```python
import torch

def _softmax(x, axis=-1):
    return torch.softmax(x, dim=axis)
def _gelu(x):
    return torch.nn.functional.gelu(x, approximate="tanh")
def _silu(x):
    return torch.nn.functional.silu(x)
def _sigmoid(x):
    return torch.sigmoid(x)
def _layernorm(x, axis=-1, eps=1e-5):
    m = x.mean(dim=axis, keepdim=True)
    v = x.var(dim=axis, keepdim=True, unbiased=False)
    return (x - m) / torch.sqrt(v + eps)
def _scatter_add(tgt, idx, src, axis=0):
    return tgt.clone().index_add_(axis, idx, src)
def _segment_sum(src, seg, n):
    out = torch.zeros((n,) + src.shape[1:], dtype=src.dtype)
    return out.index_add_(0, seg, src)
def _pad(x, pw):
    flat = tuple(v for pair in reversed(pw) for v in pair)
    return torch.nn.functional.pad(x, flat)

kernel_name = 'standalone__adm_resblock__diffusion'

def setup_inputs():

    _w = (lambda a: (lambda t: t.to(torch.bfloat16) if t.is_floating_point() else t)(torch.as_tensor(a)))
    B, C, HW, E = 2, 128, 64, 384
    sc = (9.0 * C) ** -0.5
    return {
        "x": _w((lambda *s: torch.randn(*s, dtype=torch.bfloat16) * 0.05)(B, C, HW, HW)),
        "t_emb": _w((lambda *s: torch.randn(*s, dtype=torch.bfloat16) * 0.4)(B, E)),
        "g1": _w(1.0 + 0.1 * (lambda *s: torch.randn(*s, dtype=torch.bfloat16) * 0.4)(C)),
        "be1": _w(0.1 * (lambda *s: torch.randn(*s, dtype=torch.bfloat16) * 0.4)(C)),
        "w1": _w((lambda *s: torch.randn(*s, dtype=torch.bfloat16) * 0.4)(C, C, 3, 3) * sc),
        "w_emb": _w((lambda *s: torch.randn(*s, dtype=torch.bfloat16) * 0.4)(E, C) * (E ** -0.5)),
        "g2": _w(1.0 + 0.1 * (lambda *s: torch.randn(*s, dtype=torch.bfloat16) * 0.4)(C)),
        "be2": _w(0.1 * (lambda *s: torch.randn(*s, dtype=torch.bfloat16) * 0.4)(C)),
        "w2": _w((lambda *s: torch.randn(*s, dtype=torch.bfloat16) * 0.4)(C, C, 3, 3) * sc),
    }

def reference(x, t_emb, g1, be1, w1, w_emb, g2, be2, w2):
    B, C, H, W = x.shape
    G, eps = 4, 1e-5
    def gn(z, gamma, beta):
        zr = z.reshape(B, G, (C // G) * H * W)
        mu = zr.mean(-1).reshape(B, G, 1)
        var = ((zr - mu) ** 2).mean(-1).reshape(B, G, 1)
        zn = ((zr - mu) / torch.sqrt(var + eps)).reshape(B, C, H, W)
        return zn * gamma.reshape(1, C, 1, 1) + beta.reshape(1, C, 1, 1)
    def conv3(z, w):
        zp = _pad(z, ((0, 0), (0, 0), (1, 1), (1, 1)))
        taps = [torch.einsum("bchw,oc->bohw", zp[:, :, i:i+H, j:j+W], w[:, :, i, j]) for i in range(3) for j in range(3)]
        out = taps[0]
        for t in taps[1:]:
            out = out + t
        return out
    h = conv3(_silu(gn(x, g1, be1)), w1)
    emb = _silu(t_emb) @ w_emb
    h = h + emb.reshape(B, C, 1, 1)
    h = conv3(_silu(gn(h, g2, be2)), w2)
    return x + h
```

```asm
; @launch grid=(256,1,1) block=(256,1,1) lds=53568
.amdgcn_target "amdgcn-amd-amdhsa--gfx950"
.text
.globl standalone__adm_resblock__diffusion_kernel
.p2align 8
.type standalone__adm_resblock__diffusion_kernel,@function
standalone__adm_resblock__diffusion_kernel:
  s_cmp_ge_u32 s2, 256
  s_cbranch_scc1 F_END
  s_load_dwordx16 s[36:51], s[0:1], 0
  s_load_dwordx8 s[52:59], s[0:1], 64
  v_lshrrev_b32 v2, 6, v0
  v_and_b32 v1, 63, v0
  v_readfirstlane_b32 s4, v2
  s_and_b32 s22, s2, 7
  s_lshr_b32 s5, s22, 2
  s_and_b32 s22, s22, 3
  s_lshr_b32 s9, s2, 3
  s_lshl_b32 s8, s22, 5
  s_add_u32 s8, s8, s9
  s_lshr_b32 s6, s9, 3
  s_lshl_b32 s22, s22, 2
  s_add_u32 s6, s6, s22
  s_and_b32 s7, s9, 7
  s_lshl_b32 s10, s6, 2
  s_sub_u32 s10, s10, 2
  s_lshl_b32 s11, s7, 3
  s_sub_u32 s11, s11, 2
  v_lshrrev_b32 v6, 5, v1
  v_and_b32 v7, 31, v1
  s_lshl_b32 s66, s5, 7
  s_lshl_b32 s22, s4, 5
  s_add_u32 s66, s66, s22
  s_lshl_b32 s22, s7, 4
  s_sub_u32 s22, s22, 4
  s_mov_b32 s23, 0
  s_cmp_eq_u32 s7, 0
  s_cselect_b32 s22, 0, s22
  s_cselect_b32 s23, 4, s23
  s_cmp_eq_u32 s7, 7
  s_cselect_b32 s22, 104, s22
  s_cselect_b32 s23, -4, s23
  s_lshl_b32 s21, s66, 13
  s_add_u32 s21, s21, s22
  v_lshl_add_u32 v2, v7, 13, s21
  v_add_u32 v3, s10, v6
  v_mov_b32 v5, 0x40000000
  v_cmp_gt_u32 vcc, 64, v3
  v_lshl_add_u32 v8, v3, 7, v2
  s_nop 0
  v_cndmask_b32 v8, v5, v8, vcc
  v_add_u32 v3, 2, v3
  v_cmp_gt_u32 vcc, 64, v3
  v_lshl_add_u32 v9, v3, 7, v2
  s_nop 0
  v_cndmask_b32 v9, v5, v9, vcc
  v_add_u32 v3, 2, v3
  v_cmp_gt_u32 vcc, 64, v3
  v_lshl_add_u32 v10, v3, 7, v2
  s_nop 0
  v_cndmask_b32 v10, v5, v10, vcc
  v_add_u32 v3, 2, v3
  v_cmp_gt_u32 vcc, 64, v3
  v_lshl_add_u32 v11, v3, 7, v2
  s_nop 0
  v_cndmask_b32 v11, v5, v11, vcc
  s_mul_i32 s21, s4, 6400
  s_add_u32 s21, s21, s23
  s_add_u32 s21, s21, 27920
  v_mul_u32_u24 v2, 200, v7
  v_mul_u32_u24 v3, 24, v6
  v_add3_u32 v13, v2, v3, s21
  s_mul_i32 s21, s4, 6400
  s_add_u32 s21, s21, 27972
  v_lshlrev_b32 v3, 3, v6
  v_add3_u32 v12, v2, v3, s21
  s_and_b32 s70, s2, 3
  s_lshl_b32 s22, s9, 2
  s_lshl_b32 s23, s5, 7
  s_add_u32 s23, s23, s22
  s_lshl_b32 s23, s23, 13
  s_lshl_b32 s21, s70, 11
  s_add_u32 s21, s21, s23
  v_lshl_add_u32 v14, v1, 4, s21
  s_lshl_b32 s71, s5, 5
  s_add_u32 s71, s71, s9
  s_lshl_b32 s71, s71, 2
  s_add_u32 s71, s71, s70
  s_lshl_b32 s71, s71, 4
  s_add_u32 s71, s71, 2711552
  v_and_b32 v2, 1, v1
  v_bfe_u32 v3, v1, 1, 1
  v_mul_u32_u24 v3, 18, v3
  v_add_u32 v2, v2, v3
  s_lshl_b32 s22, s70, 4
  s_sub_u32 s22, s22, 2
  v_add_u32 v2, s22, v2
  v_cmp_gt_u32 vcc, 64, v2
  v_lshl_add_u32 v2, v2, 7, s23
  v_bfe_u32 v3, v1, 2, 2
  v_lshl_add_u32 v2, v3, 13, v2
  v_bfe_u32 v3, v1, 4, 2
  v_lshl_add_u32 v2, v3, 5, v2
  v_cndmask_b32 v15, v5, v2, vcc
  s_lshl_b32 s22, s66, 13
  s_lshl_b32 s23, s6, 9
  s_add_u32 s22, s22, s23
  s_lshl_b32 s23, s7, 4
  s_add_u32 s22, s22, s23
  v_lshl_add_u32 v2, v7, 13, s22
  v_lshl_add_u32 v16, v6, 7, v2
  v_bfe_u32 v2, v1, 4, 1
  s_lshl_b32 s22, s4, 6
  v_lshl_add_u32 v17, v2, 4, s22
  v_mov_b32 v4, 2692096
  s_waitcnt lgkmcnt(0)
  s_mov_b32 s12, s58
  s_and_b32 s13, s59, 0xffff
  s_mov_b32 s14, 4194304
  s_mov_b32 s15, 0x20000
  s_mov_b32 s60, s36
  s_and_b32 s61, s37, 0xffff
  s_mov_b32 s62, 0x200000
  s_mov_b32 s63, 0x20000
  global_load_dwordx4 v[52:55], v17, s[40:41] offset:0
  global_load_dwordx4 v[60:63], v17, s[42:43] offset:0
  global_load_dwordx4 v[56:59], v17, s[40:41] offset:32
  global_load_dwordx4 v[64:67], v17, s[42:43] offset:32
  v_mov_b32 v101, 53536
  s_cmp_eq_u32 s4, 0
  s_cbranch_scc1 F_STATS
  s_cmp_lg_u32 s4, 3
  s_cbranch_scc1 F_NOJOB
  s_cmp_ge_u32 s2, 96
  s_cbranch_scc1 F_NOJOB
  s_setprio 3
  s_cmp_ge_u32 s2, 64
  s_cbranch_scc1 F_JE
  s_mov_b32 s67, s2
  s_lshr_b32 s68, s67, 5
  s_bfe_u32 s69, s67, 0x20003
  s_and_b32 s74, s67, 7
  s_lshl_b32 s75, s69, 5
  v_add_u32 v128, s75, v7
  s_movk_i32 s75, 2304
  v_mul_lo_u32 v128, v128, s75
  s_lshl_b32 s75, s74, 1
  v_add_u32 v129, s75, v6
  v_mul_u32_u24 v129, 144, v129
  v_add_u32 v128, v128, v129
  s_cmp_eq_u32 s68, 0
  s_cselect_b32 s72, s44, s52
  s_cselect_b32 s73, s45, s53
  global_load_dwordx4 v[136:139], v128, s[72:73] offset:0
  global_load_dwordx4 v[140:143], v128, s[72:73] offset:16
  global_load_dwordx4 v[144:147], v128, s[72:73] offset:32
  global_load_dwordx4 v[148:151], v128, s[72:73] offset:48
  global_load_dwordx4 v[152:155], v128, s[72:73] offset:64
  global_load_dwordx4 v[156:159], v128, s[72:73] offset:80
  global_load_dwordx4 v[160:163], v128, s[72:73] offset:96
  global_load_dwordx4 v[164:167], v128, s[72:73] offset:112
  global_load_dwordx4 v[168:171], v128, s[72:73] offset:128
  s_lshl_b32 s75, s69, 3
  s_add_u32 s75, s75, s74
  s_mul_i32 s75, s75, 9216
  s_mul_i32 s68, s68, 294912
  s_add_u32 s75, s75, s68
  s_add_u32 s75, s75, 2097152
  v_lshl_add_u32 v130, v1, 4, s75
  v_add_u32 v131, 0x1000, v130
  v_add_u32 v132, 0x2000, v130
  s_mov_b32 s68, 0x07060100
  s_mov_b32 s69, 0x05040302
  s_lshl_b32 s67, s67, 3
  s_add_u32 s67, s67, 2752512
  s_waitcnt vmcnt(0)
  v_perm_b32 v176, v140, v136, s68
  v_perm_b32 v177, v149, v145, s68
  v_perm_b32 v178, v158, v154, s68
  v_perm_b32 v179, v167, v163, s68
  global_store_dwordx4 v130, v[176:179], s[58:59] offset:0 sc0 sc1
  v_perm_b32 v180, v141, v136, s69
  v_perm_b32 v181, v150, v145, s69
  v_perm_b32 v182, v159, v154, s69
  v_perm_b32 v183, v168, v163, s69
  global_store_dwordx4 v130, v[180:183], s[58:59] offset:1024 sc0 sc1
  v_perm_b32 v184, v141, v137, s68
  v_perm_b32 v185, v150, v146, s68
  v_perm_b32 v186, v159, v155, s68
  v_perm_b32 v187, v168, v164, s68
  global_store_dwordx4 v130, v[184:187], s[58:59] offset:2048 sc0 sc1
  v_perm_b32 v176, v142, v137, s69
  v_perm_b32 v177, v151, v146, s69
  v_perm_b32 v178, v160, v155, s69
  v_perm_b32 v179, v169, v164, s69
  global_store_dwordx4 v130, v[176:179], s[58:59] offset:3072 sc0 sc1
  v_perm_b32 v180, v142, v138, s68
  v_perm_b32 v181, v151, v147, s68
  v_perm_b32 v182, v160, v156, s68
  v_perm_b32 v183, v169, v165, s68
  global_store_dwordx4 v131, v[180:183], s[58:59] offset:0 sc0 sc1
  v_perm_b32 v184, v143, v138, s69
  v_perm_b32 v185, v152, v147, s69
  v_perm_b32 v186, v161, v156, s69
  v_perm_b32 v187, v170, v165, s69
  global_store_dwordx4 v131, v[184:187], s[58:59] offset:1024 sc0 sc1
  v_perm_b32 v176, v143, v139, s68
  v_perm_b32 v177, v152, v148, s68
  v_perm_b32 v178, v161, v157, s68
  v_perm_b32 v179, v170, v166, s68
  global_store_dwordx4 v131, v[176:179], s[58:59] offset:2048 sc0 sc1
  v_perm_b32 v180, v144, v139, s69
  v_perm_b32 v181, v153, v148, s69
  v_perm_b32 v182, v162, v157, s69
  v_perm_b32 v183, v171, v166, s69
  global_store_dwordx4 v131, v[180:183], s[58:59] offset:3072 sc0 sc1
  v_perm_b32 v184, v144, v140, s68
  v_perm_b32 v185, v153, v149, s68
  v_perm_b32 v186, v162, v158, s68
  v_perm_b32 v187, v171, v167, s68
  global_store_dwordx4 v132, v[184:187], s[58:59] offset:0 sc0 sc1
  buffer_load_dwordx4 v[20:23], v8, s[60:63], 0 offen
  buffer_load_dwordx2 v[36:37], v8, s[60:63], 0 offen offset:16
  buffer_load_dwordx4 v[24:27], v9, s[60:63], 0 offen
  buffer_load_dwordx2 v[38:39], v9, s[60:63], 0 offen offset:16
  buffer_load_dwordx4 v[28:31], v10, s[60:63], 0 offen
  buffer_load_dwordx2 v[40:41], v10, s[60:63], 0 offen offset:16
  buffer_load_dwordx4 v[32:35], v11, s[60:63], 0 offen
  buffer_load_dwordx2 v[42:43], v11, s[60:63], 0 offen offset:16
  v_lshl_add_u32 v128, v1, 10, s67
  s_branch F_TAG
F_JE:
  s_sub_u32 s67, s2, 64
  s_lshr_b32 s68, s67, 4
  s_and_b32 s69, s67, 15
  s_mul_i32 s74, s68, 768
  v_lshl_add_u32 v128, v1, 1, s74
  s_lshl_b32 s74, s69, 4
  v_lshl_add_u32 v129, v1, 8, s74
  v_add_u32 v130, 16384, v129
  v_add_u32 v131, 32768, v129
  v_add_u32 v132, 49152, v129
  v_add_u32 v133, 65536, v129
  v_add_u32 v134, 81920, v129
  global_load_ushort v136, v128, s[38:39] offset:0
  global_load_ushort v137, v128, s[38:39] offset:128
  global_load_ushort v138, v128, s[38:39] offset:256
  global_load_ushort v139, v128, s[38:39] offset:384
  global_load_ushort v140, v128, s[38:39] offset:512
  global_load_ushort v141, v128, s[38:39] offset:640
  global_load_dwordx4 v[144:147], v129, s[46:47]
  global_load_dwordx4 v[148:151], v130, s[46:47]
  global_load_dwordx4 v[152:155], v131, s[46:47]
  global_load_dwordx4 v[156:159], v132, s[46:47]
  global_load_dwordx4 v[160:163], v133, s[46:47]
  global_load_dwordx4 v[164:167], v134, s[46:47]
  s_lshl_b32 s74, s68, 9
  s_lshl_b32 s75, s69, 5
  s_add_u32 s74, s74, s75
  s_add_u32 s74, s74, 2693120
  v_mov_b32 v168, 0
  v_mov_b32 v169, 0
  v_mov_b32 v170, 0
  v_mov_b32 v171, 0
  v_mov_b32 v172, 0
  v_mov_b32 v173, 0
  v_mov_b32 v174, 0
  v_mov_b32 v175, 0
  s_mov_b32 s68, 0xbfb8aa3b
  s_mov_b32 s69, 0xffff0000
  s_waitcnt vmcnt(6)
  v_lshlrev_b32 v136, 16, v136
  v_lshlrev_b32 v137, 16, v137
  v_lshlrev_b32 v138, 16, v138
  v_lshlrev_b32 v139, 16, v139
  v_lshlrev_b32 v140, 16, v140
  v_lshlrev_b32 v141, 16, v141
  v_mul_f32 v178, s68, v136
  v_mul_f32 v179, s68, v137
  v_mul_f32 v180, s68, v138
  v_mul_f32 v181, s68, v139
  v_mul_f32 v182, s68, v140
  v_mul_f32 v183, s68, v141
  v_exp_f32 v178, v178
  v_exp_f32 v179, v179
  v_exp_f32 v180, v180
  v_exp_f32 v181, v181
  v_exp_f32 v182, v182
  v_exp_f32 v183, v183
  v_add_f32 v178, 1.0, v178
  v_add_f32 v179, 1.0, v179
  v_add_f32 v180, 1.0, v180
  v_add_f32 v181, 1.0, v181
  v_add_f32 v182, 1.0, v182
  v_add_f32 v183, 1.0, v183
  v_rcp_f32 v178, v178
  v_rcp_f32 v179, v179
  v_rcp_f32 v180, v180
  v_rcp_f32 v181, v181
  v_rcp_f32 v182, v182
  v_rcp_f32 v183, v183
  v_mul_f32 v136, v136, v178
  v_mul_f32 v137, v137, v179
  v_mul_f32 v138, v138, v180
  v_mul_f32 v139, v139, v181
  v_mul_f32 v140, v140, v182
  v_mul_f32 v141, v141, v183
  s_waitcnt vmcnt(5)
  v_lshlrev_b32 v184, 16, v144
  v_and_b32 v185, s69, v144
  v_fmac_f32 v168, v136, v184
  v_fmac_f32 v169, v136, v185
  v_lshlrev_b32 v184, 16, v145
  v_and_b32 v185, s69, v145
  v_fmac_f32 v170, v136, v184
  v_fmac_f32 v171, v136, v185
  v_lshlrev_b32 v184, 16, v146
  v_and_b32 v185, s69, v146
  v_fmac_f32 v172, v136, v184
  v_fmac_f32 v173, v136, v185
  v_lshlrev_b32 v184, 16, v147
  v_and_b32 v185, s69, v147
  v_fmac_f32 v174, v136, v184
  v_fmac_f32 v175, v136, v185
  s_waitcnt vmcnt(4)
  v_lshlrev_b32 v184, 16, v148
  v_and_b32 v185, s69, v148
  v_fmac_f32 v168, v137, v184
  v_fmac_f32 v169, v137, v185
  v_lshlrev_b32 v184, 16, v149
  v_and_b32 v185, s69, v149
  v_fmac_f32 v170, v137, v184
  v_fmac_f32 v171, v137, v185
  v_lshlrev_b32 v184, 16, v150
  v_and_b32 v185, s69, v150
  v_fmac_f32 v172, v137, v184
  v_fmac_f32 v173, v137, v185
  v_lshlrev_b32 v184, 16, v151
  v_and_b32 v185, s69, v151
  v_fmac_f32 v174, v137, v184
  v_fmac_f32 v175, v137, v185
  s_waitcnt vmcnt(3)
  v_lshlrev_b32 v184, 16, v152
  v_and_b32 v185, s69, v152
  v_fmac_f32 v168, v138, v184
  v_fmac_f32 v169, v138, v185
  v_lshlrev_b32 v184, 16, v153
  v_and_b32 v185, s69, v153
  v_fmac_f32 v170, v138, v184
  v_fmac_f32 v171, v138, v185
  v_lshlrev_b32 v184, 16, v154
  v_and_b32 v185, s69, v154
  v_fmac_f32 v172, v138, v184
  v_fmac_f32 v173, v138, v185
  v_lshlrev_b32 v184, 16, v155
  v_and_b32 v185, s69, v155
  v_fmac_f32 v174, v138, v184
  v_fmac_f32 v175, v138, v185
  s_waitcnt vmcnt(2)
  v_lshlrev_b32 v184, 16, v156
  v_and_b32 v185, s69, v156
  v_fmac_f32 v168, v139, v184
  v_fmac_f32 v169, v139, v185
  v_lshlrev_b32 v184, 16, v157
  v_and_b32 v185, s69, v157
  v_fmac_f32 v170, v139, v184
  v_fmac_f32 v171, v139, v185
  v_lshlrev_b32 v184, 16, v158
  v_and_b32 v185, s69, v158
  v_fmac_f32 v172, v139, v184
  v_fmac_f32 v173, v139, v185
  v_lshlrev_b32 v184, 16, v159
  v_and_b32 v185, s69, v159
  v_fmac_f32 v174, v139, v184
  v_fmac_f32 v175, v139, v185
  s_waitcnt vmcnt(1)
  v_lshlrev_b32 v184, 16, v160
  v_and_b32 v185, s69, v160
  v_fmac_f32 v168, v140, v184
  v_fmac_f32 v169, v140, v185
  v_lshlrev_b32 v184, 16, v161
  v_and_b32 v185, s69, v161
  v_fmac_f32 v170, v140, v184
  v_fmac_f32 v171, v140, v185
  v_lshlrev_b32 v184, 16, v162
  v_and_b32 v185, s69, v162
  v_fmac_f32 v172, v140, v184
  v_fmac_f32 v173, v140, v185
  v_lshlrev_b32 v184, 16, v163
  v_and_b32 v185, s69, v163
  v_fmac_f32 v174, v140, v184
  v_fmac_f32 v175, v140, v185
  s_waitcnt vmcnt(0)
  v_lshlrev_b32 v184, 16, v164
  v_and_b32 v185, s69, v164
  v_fmac_f32 v168, v141, v184
  v_fmac_f32 v169, v141, v185
  v_lshlrev_b32 v184, 16, v165
  v_and_b32 v185, s69, v165
  v_fmac_f32 v170, v141, v184
  v_fmac_f32 v171, v141, v185
  v_lshlrev_b32 v184, 16, v166
  v_and_b32 v185, s69, v166
  v_fmac_f32 v172, v141, v184
  v_fmac_f32 v173, v141, v185
  v_lshlrev_b32 v184, 16, v167
  v_and_b32 v185, s69, v167
  v_fmac_f32 v174, v141, v184
  v_fmac_f32 v175, v141, v185
  v_add_f32_dpp v168, v168, v168 row_ror:8 row_mask:0xf bank_mask:0xf
  v_add_f32_dpp v169, v169, v169 row_ror:8 row_mask:0xf bank_mask:0xf
  v_add_f32_dpp v170, v170, v170 row_ror:8 row_mask:0xf bank_mask:0xf
  v_add_f32_dpp v171, v171, v171 row_ror:8 row_mask:0xf bank_mask:0xf
  v_add_f32_dpp v172, v172, v172 row_ror:8 row_mask:0xf bank_mask:0xf
  v_add_f32_dpp v173, v173, v173 row_ror:8 row_mask:0xf bank_mask:0xf
  v_add_f32_dpp v174, v174, v174 row_ror:8 row_mask:0xf bank_mask:0xf
  v_add_f32_dpp v175, v175, v175 row_ror:8 row_mask:0xf bank_mask:0xf
  v_add_f32_dpp v168, v168, v168 row_ror:4 row_mask:0xf bank_mask:0xf
  v_add_f32_dpp v169, v169, v169 row_ror:4 row_mask:0xf bank_mask:0xf
  v_add_f32_dpp v170, v170, v170 row_ror:4 row_mask:0xf bank_mask:0xf
  v_add_f32_dpp v171, v171, v171 row_ror:4 row_mask:0xf bank_mask:0xf
  v_add_f32_dpp v172, v172, v172 row_ror:4 row_mask:0xf bank_mask:0xf
  v_add_f32_dpp v173, v173, v173 row_ror:4 row_mask:0xf bank_mask:0xf
  v_add_f32_dpp v174, v174, v174 row_ror:4 row_mask:0xf bank_mask:0xf
  v_add_f32_dpp v175, v175, v175 row_ror:4 row_mask:0xf bank_mask:0xf
  v_add_f32_dpp v168, v168, v168 row_ror:2 row_mask:0xf bank_mask:0xf
  v_add_f32_dpp v169, v169, v169 row_ror:2 row_mask:0xf bank_mask:0xf
  v_add_f32_dpp v170, v170, v170 row_ror:2 row_mask:0xf bank_mask:0xf
  v_add_f32_dpp v171, v171, v171 row_ror:2 row_mask:0xf bank_mask:0xf
  v_add_f32_dpp v172, v172, v172 row_ror:2 row_mask:0xf bank_mask:0xf
  v_add_f32_dpp v173, v173, v173 row_ror:2 row_mask:0xf bank_mask:0xf
  v_add_f32_dpp v174, v174, v174 row_ror:2 row_mask:0xf bank_mask:0xf
  v_add_f32_dpp v175, v175, v175 row_ror:2 row_mask:0xf bank_mask:0xf
  v_add_f32_dpp v168, v168, v168 row_ror:1 row_mask:0xf bank_mask:0xf
  v_add_f32_dpp v169, v169, v169 row_ror:1 row_mask:0xf bank_mask:0xf
  v_add_f32_dpp v170, v170, v170 row_ror:1 row_mask:0xf bank_mask:0xf
  v_add_f32_dpp v171, v171, v171 row_ror:1 row_mask:0xf bank_mask:0xf
  v_add_f32_dpp v172, v172, v172 row_ror:1 row_mask:0xf bank_mask:0xf
  v_add_f32_dpp v173, v173, v173 row_ror:1 row_mask:0xf bank_mask:0xf
  v_add_f32_dpp v174, v174, v174 row_ror:1 row_mask:0xf bank_mask:0xf
  v_add_f32_dpp v175, v175, v175 row_ror:1 row_mask:0xf bank_mask:0xf
  v_mov_b32 v178, v168
  v_mov_b32 v179, v169
  v_mov_b32 v180, v170
  v_mov_b32 v181, v171
  v_mov_b32 v182, v172
  v_mov_b32 v183, v173
  v_mov_b32 v184, v174
  v_mov_b32 v185, v175
  v_permlane16_swap_b32 v168, v178
  v_permlane16_swap_b32 v169, v179
  v_permlane16_swap_b32 v170, v180
  v_permlane16_swap_b32 v171, v181
  v_permlane16_swap_b32 v172, v182
  v_permlane16_swap_b32 v173, v183
  v_permlane16_swap_b32 v174, v184
  v_permlane16_swap_b32 v175, v185
  v_add_f32 v168, v168, v178
  v_add_f32 v169, v169, v179
  v_add_f32 v170, v170, v180
  v_add_f32 v171, v171, v181
  v_add_f32 v172, v172, v182
  v_add_f32 v173, v173, v183
  v_add_f32 v174, v174, v184
  v_add_f32 v175, v175, v185
  v_mov_b32 v178, v168
  v_mov_b32 v179, v169
  v_mov_b32 v180, v170
  v_mov_b32 v181, v171
  v_mov_b32 v182, v172
  v_mov_b32 v183, v173
  v_mov_b32 v184, v174
  v_mov_b32 v185, v175
  v_permlane32_swap_b32 v168, v178
  v_permlane32_swap_b32 v169, v179
  v_permlane32_swap_b32 v170, v180
  v_permlane32_swap_b32 v171, v181
  v_permlane32_swap_b32 v172, v182
  v_permlane32_swap_b32 v173, v183
  v_permlane32_swap_b32 v174, v184
  v_permlane32_swap_b32 v175, v185
  v_add_f32 v168, v168, v178
  v_add_f32 v169, v169, v179
  v_add_f32 v170, v170, v180
  v_add_f32 v171, v171, v181
  v_add_f32 v172, v172, v182
  v_add_f32 v173, v173, v183
  v_add_f32 v174, v174, v184
  v_add_f32 v175, v175, v185
  v_mov_b32 v128, s74
  s_mov_b64 exec, 1
  global_store_dwordx4 v128, v[168:171], s[58:59] sc0 sc1
  global_store_dwordx4 v128, v[172:175], s[58:59] offset:16 sc0 sc1
  s_mov_b64 exec, -1
  s_barrier
  buffer_load_dwordx4 v[20:23], v8, s[60:63], 0 offen
  buffer_load_dwordx2 v[36:37], v8, s[60:63], 0 offen offset:16
  buffer_load_dwordx4 v[24:27], v9, s[60:63], 0 offen
  buffer_load_dwordx2 v[38:39], v9, s[60:63], 0 offen offset:16
  buffer_load_dwordx4 v[28:31], v10, s[60:63], 0 offen
  buffer_load_dwordx2 v[40:41], v10, s[60:63], 0 offen offset:16
  buffer_load_dwordx4 v[32:35], v11, s[60:63], 0 offen
  buffer_load_dwordx2 v[42:43], v11, s[60:63], 0 offen offset:16
  ds_read_b64 v[18:19], v101
  s_waitcnt lgkmcnt(0)
  v_readfirstlane_b32 s64, v18
  v_readfirstlane_b32 s65, v19
  s_setprio 0
  s_mov_b32 s3, 2
  s_branch F_COMMON
  s_nop 7
  s_nop 3
F_TAG:
  s_barrier
  ds_read_b64 v[18:19], v101
  s_waitcnt lgkmcnt(0)
  v_readfirstlane_b32 s64, v18
  v_readfirstlane_b32 s65, v19
  s_nop 0
  v_mov_b32 v134, s64
  v_mov_b32 v135, s65
  s_waitcnt vmcnt(8)
  s_mov_b64 exec, 0xffffffff
  global_store_dwordx2 v128, v[134:135], s[58:59] sc0 sc1
  s_mov_b64 exec, -1
  s_setprio 0
  s_mov_b32 s3, 1
  s_branch F_COMMON
F_STATS:
  global_load_dwordx2 v[18:19], v4, s[58:59] sc0 sc1
  s_lshl_b32 s22, s5, 12
  s_lshl_b32 s23, s8, 3
  s_add_u32 s22, s22, s23
  s_add_u32 s22, s22, 2695168
  v_lshl_add_u32 v106, v1, 10, s22
  v_mov_b32 v108, 0
  v_mov_b32 v109, -1
  s_mov_b64 exec, 15
  global_store_dwordx2 v106, v[108:109], s[58:59] sc0 sc1
  s_mov_b64 exec, -1
  buffer_load_dwordx4 v[68:71], v14, s[60:63], 0 offen offset:0
  buffer_load_dwordx4 v[72:75], v14, s[60:63], 0 offen offset:1024
  v_add_u32 v14, 0x2000, v14
  buffer_load_dwordx4 v[76:79], v14, s[60:63], 0 offen offset:0
  buffer_load_dwordx4 v[80:83], v14, s[60:63], 0 offen offset:1024
  v_add_u32 v14, 0x2000, v14
  buffer_load_dwordx4 v[84:87], v14, s[60:63], 0 offen offset:0
  buffer_load_dwordx4 v[88:91], v14, s[60:63], 0 offen offset:1024
  v_add_u32 v14, 0x2000, v14
  buffer_load_dwordx4 v[92:95], v14, s[60:63], 0 offen offset:0
  buffer_load_dwordx4 v[96:99], v14, s[60:63], 0 offen offset:1024
  buffer_load_dword v100, v15, s[60:63], 0 offen
  s_mov_b32 s22, 0x3f803f80
  v_mov_b32 v102, 0
  v_mov_b32 v103, 0
  v_mov_b32 v104, 0
  v_mov_b32 v105, 0
  s_waitcnt vmcnt(10)
  v_readfirstlane_b32 s64, v18
  v_readfirstlane_b32 s65, v19
  s_nop 0
  s_add_u32 s64, s64, 0x9e3779b9
  s_add_u32 s65, s65, 0x7f4a7c15
  v_mov_b32 v18, s64
  v_mov_b32 v19, s65
  ds_write_b64 v101, v[18:19]
  s_waitcnt vmcnt(7)
  v_dot2_f32_bf16 v102, v68, s22, v102
  v_dot2_f32_bf16 v104, v68, v68, v104
  v_dot2_f32_bf16 v103, v69, s22, v103
  v_dot2_f32_bf16 v105, v69, v69, v105
  v_dot2_f32_bf16 v102, v70, s22, v102
  v_dot2_f32_bf16 v104, v70, v70, v104
  v_dot2_f32_bf16 v103, v71, s22, v103
  v_dot2_f32_bf16 v105, v71, v71, v105
  v_dot2_f32_bf16 v102, v72, s22, v102
  v_dot2_f32_bf16 v104, v72, v72, v104
  v_dot2_f32_bf16 v103, v73, s22, v103
  v_dot2_f32_bf16 v105, v73, v73, v105
  v_dot2_f32_bf16 v102, v74, s22, v102
  v_dot2_f32_bf16 v104, v74, v74, v104
  v_dot2_f32_bf16 v103, v75, s22, v103
  v_dot2_f32_bf16 v105, v75, v75, v105
  s_waitcnt vmcnt(5)
  v_dot2_f32_bf16 v102, v76, s22, v102
  v_dot2_f32_bf16 v104, v76, v76, v104
  v_dot2_f32_bf16 v103, v77, s22, v103
  v_dot2_f32_bf16 v105, v77, v77, v105
  v_dot2_f32_bf16 v102, v78, s22, v102
  v_dot2_f32_bf16 v104, v78, v78, v104
  v_dot2_f32_bf16 v103, v79, s22, v103
  v_dot2_f32_bf16 v105, v79, v79, v105
  v_dot2_f32_bf16 v102, v80, s22, v102
  v_dot2_f32_bf16 v104, v80, v80, v104
  v_dot2_f32_bf16 v103, v81, s22, v103
  v_dot2_f32_bf16 v105, v81, v81, v105
  v_dot2_f32_bf16 v102, v82, s22, v102
  v_dot2_f32_bf16 v104, v82, v82, v104
  v_dot2_f32_bf16 v103, v83, s22, v103
  v_dot2_f32_bf16 v105, v83, v83, v105
  s_waitcnt vmcnt(3)
  v_dot2_f32_bf16 v102, v84, s22, v102
  v_dot2_f32_bf16 v104, v84, v84, v104
  v_dot2_f32_bf16 v103, v85, s22, v103
  v_dot2_f32_bf16 v105, v85, v85, v105
  v_dot2_f32_bf16 v102, v86, s22, v102
  v_dot2_f32_bf16 v104, v86, v86, v104
  v_dot2_f32_bf16 v103, v87, s22, v103
  v_dot2_f32_bf16 v105, v87, v87, v105
  v_dot2_f32_bf16 v102, v88, s22, v102
  v_dot2_f32_bf16 v104, v88, v88, v104
  v_dot2_f32_bf16 v103, v89, s22, v103
  v_dot2_f32_bf16 v105, v89, v89, v105
  v_dot2_f32_bf16 v102, v90, s22, v102
  v_dot2_f32_bf16 v104, v90, v90, v104
  v_dot2_f32_bf16 v103, v91, s22, v103
  v_dot2_f32_bf16 v105, v91, v91, v105
  s_waitcnt vmcnt(1)
  v_dot2_f32_bf16 v102, v92, s22, v102
  v_dot2_f32_bf16 v104, v92, v92, v104
  v_dot2_f32_bf16 v103, v93, s22, v103
  v_dot2_f32_bf16 v105, v93, v93, v105
  v_dot2_f32_bf16 v102, v94, s22, v102
  v_dot2_f32_bf16 v104, v94, v94, v104
  v_dot2_f32_bf16 v103, v95, s22, v103
  v_dot2_f32_bf16 v105, v95, v95, v105
  v_dot2_f32_bf16 v102, v96, s22, v102
  v_dot2_f32_bf16 v104, v96, v96, v104
  v_dot2_f32_bf16 v103, v97, s22, v103
  v_dot2_f32_bf16 v105, v97, v97, v105
  v_dot2_f32_bf16 v102, v98, s22, v102
  v_dot2_f32_bf16 v104, v98, v98, v104
  v_dot2_f32_bf16 v103, v99, s22, v103
  v_dot2_f32_bf16 v105, v99, v99, v105
  s_nop 1
  v_add_f32 v102, v102, v103
  v_add_f32 v103, v104, v105
  s_nop 0
  v_add_f32_dpp v102, v102, v102 row_ror:8 row_mask:0xf bank_mask:0xf
  v_add_f32_dpp v103, v103, v103 row_ror:8 row_mask:0xf bank_mask:0xf
  s_nop 0
  v_add_f32_dpp v102, v102, v102 row_ror:4 row_mask:0xf bank_mask:0xf
  v_add_f32_dpp v103, v103, v103 row_ror:4 row_mask:0xf bank_mask:0xf
  s_nop 0
  v_add_f32_dpp v102, v102, v102 row_ror:2 row_mask:0xf bank_mask:0xf
  v_add_f32_dpp v103, v103, v103 row_ror:2 row_mask:0xf bank_mask:0xf
  s_nop 0
  v_add_f32_dpp v102, v102, v102 row_ror:1 row_mask:0xf bank_mask:0xf
  v_add_f32_dpp v103, v103, v103 row_ror:1 row_mask:0xf bank_mask:0xf
  v_mov_b32 v104, v102
  v_mov_b32 v105, v103
  s_nop 0
  v_permlane16_swap_b32 v102, v104
  v_permlane16_swap_b32 v103, v105
  v_add_f32 v102, v102, v104
  v_add_f32 v103, v103, v105
  v_mov_b32 v104, v102
  v_mov_b32 v105, v103
  s_nop 0
  v_permlane32_swap_b32 v102, v104
  v_permlane32_swap_b32 v103, v105
  v_add_f32 v102, v102, v104
  v_add_f32 v103, v103, v105
  v_mov_b32 v104, s64
  v_mov_b32 v105, s65
  v_mov_b32 v106, s71
  s_mov_b64 exec, 1
  global_store_dwordx4 v106, v[102:105], s[58:59] sc0 sc1
  s_mov_b64 exec, -1
  s_waitcnt lgkmcnt(0)
  s_barrier
  buffer_load_dwordx4 v[20:23], v8, s[60:63], 0 offen
  buffer_load_dwordx2 v[36:37], v8, s[60:63], 0 offen offset:16
  buffer_load_dwordx4 v[24:27], v9, s[60:63], 0 offen
  buffer_load_dwordx2 v[38:39], v9, s[60:63], 0 offen offset:16
  buffer_load_dwordx4 v[28:31], v10, s[60:63], 0 offen
  buffer_load_dwordx2 v[40:41], v10, s[60:63], 0 offen offset:16
  buffer_load_dwordx4 v[32:35], v11, s[60:63], 0 offen
  buffer_load_dwordx2 v[42:43], v11, s[60:63], 0 offen offset:16
  s_mov_b32 s3, 0
  s_branch F_COMMON
F_NOJOB:
  s_barrier
  buffer_load_dwordx4 v[20:23], v8, s[60:63], 0 offen
  buffer_load_dwordx2 v[36:37], v8, s[60:63], 0 offen offset:16
  buffer_load_dwordx4 v[24:27], v9, s[60:63], 0 offen
  buffer_load_dwordx2 v[38:39], v9, s[60:63], 0 offen offset:16
  buffer_load_dwordx4 v[28:31], v10, s[60:63], 0 offen
  buffer_load_dwordx2 v[40:41], v10, s[60:63], 0 offen offset:16
  buffer_load_dwordx4 v[32:35], v11, s[60:63], 0 offen
  buffer_load_dwordx2 v[42:43], v11, s[60:63], 0 offen offset:16
  ds_read_b64 v[18:19], v101
  s_waitcnt lgkmcnt(0)
  v_readfirstlane_b32 s64, v18
  v_readfirstlane_b32 s65, v19
  s_mov_b32 s3, 0
  s_nop 7
  s_nop 3
F_COMMON:
  s_mov_b32 s16, 0xbfb8aa3b
  s_mov_b32 s17, 0xbfb8aa3b
  s_mov_b32 s18, 1.0
  s_mov_b32 s19, 1.0
  s_mov_b32 s20, 0xffff0000
  v_and_b32 v5, 15, v1
  v_lshl_add_u32 v5, v6, 4, v5
  v_add_u32 v2, 0, v5
  v_mul_u32_u24 v3, 171, v2
  v_lshrrev_b32 v3, 11, v3
  v_mul_u32_u24 v4, 12, v3
  v_sub_u32 v2, v2, v4
  v_mul_u32_u24 v110, 3488, v3
  v_mul_u32_u24 v4, 272, v2
  v_add3_u32 v110, v110, v4, v17
  v_add_u32 v3, s10, v3
  v_add_u32 v2, s11, v2
  v_or_b32 v2, v2, v3
  v_cmp_gt_u32 s[24:25], 64, v2
  v_add_u32 v2, 32, v5
  v_mul_u32_u24 v3, 171, v2
  v_lshrrev_b32 v3, 11, v3
  v_mul_u32_u24 v4, 12, v3
  v_sub_u32 v2, v2, v4
  v_mul_u32_u24 v111, 3488, v3
  v_mul_u32_u24 v4, 272, v2
  v_add3_u32 v111, v111, v4, v17
  v_add_u32 v3, s10, v3
  v_add_u32 v2, s11, v2
  v_or_b32 v2, v2, v3
  v_cmp_gt_u32 s[26:27], 64, v2
  v_add_u32 v2, 64, v5
  v_mul_u32_u24 v3, 171, v2
  v_lshrrev_b32 v3, 11, v3
  v_mul_u32_u24 v4, 12, v3
  v_sub_u32 v2, v2, v4
  v_mul_u32_u24 v112, 3488, v3
  v_mul_u32_u24 v4, 272, v2
  v_add3_u32 v112, v112, v4, v17
  v_add_u32 v3, s10, v3
  v_add_u32 v2, s11, v2
  v_or_b32 v2, v2, v3
  v_cmp_gt_u32 s[28:29], 64, v2
  v_bfe_u32 v2, v1, 4, 1
  v_bfe_u32 v3, v1, 2, 2
  v_lshl_add_u32 v2, v2, 3, v3
  v_mul_u32_u24 v2, 200, v2
  v_and_b32 v3, 3, v1
  v_lshl_add_u32 v2, v3, 3, v2
  v_lshl_add_u32 v2, v6, 5, v2
  s_mul_i32 s22, s4, 6400
  s_add_u32 s22, s22, 27920
  v_add_u32 v113, s22, v2
  s_lshl_b32 s22, s66, 4
  s_add_u32 s22, s22, 2711552
  v_lshl_add_u32 v114, v7, 4, s22
  v_min_u32 v2, 31, v1
  v_lshlrev_b32 v2, 4, v2
  s_and_b32 s22, s2, 31
  s_lshl_b32 s22, s22, 10
  s_add_u32 s22, s22, 2752512
  v_add_u32 v115, s22, v2
  v_min_u32 v2, 15, v1
  v_lshlrev_b32 v2, 4, v2
  s_add_u32 s22, s22, 512
  v_add_u32 v116, s22, v2
  s_mul_i32 s22, s4, 73728
  v_lshl_add_u32 v117, v1, 4, s22
  v_mov_b32 v2, v7
  v_mul_u32_u24 v3, 205, v2
  v_lshrrev_b32 v3, 11, v3
  v_mul_u32_u24 v4, 10, v3
  v_sub_u32 v2, v2, v4
  v_mul_u32_u24 v4, 272, v2
  v_mul_u32_u24 v118, 3488, v3
  v_lshl_add_u32 v5, v6, 4, v4
  v_add_u32 v118, v118, v5
  v_mul_u32_u24 v120, 2944, v3
  v_lshl_add_u32 v5, v6, 3, v4
  v_add_u32 v120, v120, v5
  s_lshl_b32 s22, s4, 6
  s_add_u32 s22, s22, 27904
  v_add_u32 v120, s22, v120
  v_subrev_u32 v4, 1, v3
  v_subrev_u32 v5, 1, v2
  v_cmp_gt_u32 vcc, 4, v4
  v_cmp_gt_u32 s[72:73], 8, v5
  s_nop 1
  s_and_b64 s[72:73], s[72:73], vcc
  s_add_u32 s22, s10, 1
  s_add_u32 s23, s11, 1
  v_add_u32 v3, s22, v3
  v_add_u32 v2, s23, v2
  v_or_b32 v2, v2, v3
  v_cmp_gt_u32 s[76:77], 64, v2
  v_add_u32 v2, 32, v7
  v_cmp_gt_u32 s[80:81], 60, v2
  v_subrev_u32 v3, 16, v2
  s_nop 0
  v_cndmask_b32 v2, v3, v2, s[80:81]
  v_mul_u32_u24 v3, 205, v2
  v_lshrrev_b32 v3, 11, v3
  v_mul_u32_u24 v4, 10, v3
  v_sub_u32 v2, v2, v4
  v_mul_u32_u24 v4, 272, v2
  v_mul_u32_u24 v119, 3488, v3
  v_lshl_add_u32 v5, v6, 4, v4
  v_add_u32 v119, v119, v5
  v_mul_u32_u24 v121, 2944, v3
  v_lshl_add_u32 v5, v6, 3, v4
  v_add_u32 v121, v121, v5
  s_lshl_b32 s22, s4, 6
  s_add_u32 s22, s22, 27904
  v_add_u32 v121, s22, v121
  v_subrev_u32 v4, 1, v3
  v_subrev_u32 v5, 1, v2
  v_cmp_gt_u32 vcc, 4, v4
  v_cmp_gt_u32 s[74:75], 8, v5
  s_nop 1
  s_and_b64 s[74:75], s[74:75], vcc
  s_and_b64 s[74:75], s[74:75], s[80:81]
  s_add_u32 s22, s10, 1
  s_add_u32 s23, s11, 1
  v_add_u32 v3, s22, v3
  v_add_u32 v2, s23, v2
  v_or_b32 v2, v2, v3
  v_cmp_gt_u32 s[78:79], 64, v2
  v_lshrrev_b32 v2, 3, v7
  v_mul_u32_u24 v2, 2944, v2
  v_and_b32 v3, 7, v7
  v_mul_u32_u24 v3, 272, v3
  v_lshlrev_b32 v4, 4, v6
  v_add3_u32 v122, v2, v3, v4
  v_add_u32 v122, 27904, v122
  s_lshl_b32 s22, s5, 2
  s_add_u32 s22, s22, s4
  s_lshl_b32 s22, s22, 10
  s_add_u32 s22, s22, 2695168
  v_lshl_add_u32 v123, v1, 4, s22
  s_lshl_b32 s23, s8, 3
  s_add_u32 s22, s22, s23
  v_mov_b32 v124, s22
  s_mul_i32 s22, s9, 18432
  s_mul_i32 s23, s4, 5120
  s_add_u32 s22, s22, s23
  s_add_u32 s22, s22, 2097152
  v_lshl_add_u32 v125, v1, 4, s22
  s_lshl_b32 s22, s5, 9
  s_lshl_b32 s23, s4, 7
  s_add_u32 s22, s22, s23
  s_add_u32 s22, s22, 2693120
  v_lshl_add_u32 v126, v6, 4, s22
  s_lshl_b32 s22, s4, 6
  v_lshl_add_u32 v127, v6, 3, s22
  s_cmp_eq_u32 s3, 2
  s_waitcnt vmcnt(0)
  s_cbranch_scc1 F_STAGE
  s_cmp_eq_u32 s3, 1
  s_waitcnt vmcnt(1)
  s_cbranch_scc1 F_STAGE
  s_waitcnt vmcnt(0)
F_STAGE:
  ds_write2_b32 v13, v20, v21 offset0:0 offset1:1
  ds_write2_b32 v13, v22, v23 offset0:2 offset1:3
  ds_write2_b32 v13, v36, v37 offset0:4 offset1:5
  ds_write2_b32 v13, v24, v25 offset0:12 offset1:13
  ds_write2_b32 v13, v26, v27 offset0:14 offset1:15
  ds_write2_b32 v13, v38, v39 offset0:16 offset1:17
  ds_write2_b32 v13, v28, v29 offset0:24 offset1:25
  ds_write2_b32 v13, v30, v31 offset0:26 offset1:27
  ds_write2_b32 v13, v40, v41 offset0:28 offset1:29
  ds_write2_b32 v13, v32, v33 offset0:36 offset1:37
  ds_write2_b32 v13, v34, v35 offset0:38 offset1:39
  ds_write2_b32 v13, v42, v43 offset0:40 offset1:41
  s_waitcnt lgkmcnt(0)
  ds_read2_b32 v[44:45], v12 offset0:0 offset1:1
  ds_read2_b32 v[46:47], v12 offset0:6 offset1:7
  ds_read2_b32 v[48:49], v12 offset0:12 offset1:13
  ds_read2_b32 v[50:51], v12 offset0:18 offset1:19
  ds_read_b64_tr_b16 v[18:19], v113 offset:0
  ds_read_b64_tr_b16 v[20:21], v113 offset:800
  ds_read_b64_tr_b16 v[22:23], v113 offset:64
  ds_read_b64_tr_b16 v[24:25], v113 offset:864
  ds_read_b64_tr_b16 v[26:27], v113 offset:128
  ds_read_b64_tr_b16 v[28:29], v113 offset:928
  ds_read_b64_tr_b16 v[30:31], v113 offset:3200
  ds_read_b64_tr_b16 v[32:33], v113 offset:4000
  ds_read_b64_tr_b16 v[34:35], v113 offset:3264
  ds_read_b64_tr_b16 v[36:37], v113 offset:4064
  ds_read_b64_tr_b16 v[38:39], v113 offset:3328
  ds_read_b64_tr_b16 v[40:41], v113 offset:4128
  s_waitcnt lgkmcnt(0)
  s_mov_b32 s82, 65536
  s_nop 7
  s_nop 3
F_POLL1:
  buffer_load_dwordx4 v[152:155], v114, s[12:15], 0 offen sc0 sc1
  s_waitcnt vmcnt(0)
  v_cmp_eq_u64 vcc, s[64:65], v[154:155]
  s_sub_u32 s82, s82, 1
  s_cbranch_scc1 F_GO1
  s_cmp_eq_u64 vcc, -1
  s_cbranch_scc0 F_POLL1
F_GO1:
  s_cmp_lg_u32 s3, 2
  s_cbranch_scc1 F_NOTE
  s_sub_u32 s22, s2, 64
  s_lshl_b32 s22, s22, 3
  s_add_u32 s22, s22, 2753024
  v_lshl_add_u32 v2, v1, 10, s22
  v_mov_b32 v160, s64
  v_mov_b32 v161, s65
  s_mov_b64 exec, 0xffffffff
  global_store_dwordx2 v2, v[160:161], s[58:59] sc0 sc1
  s_mov_b64 exec, -1
F_NOTE:
  v_add_u32 v5, 0x1000, v125
  v_add_f32_dpp v152, v152, v152 row_ror:8 row_mask:0xf bank_mask:0xf
  v_add_f32_dpp v153, v153, v153 row_ror:8 row_mask:0xf bank_mask:0xf
  s_nop 0
  v_add_f32_dpp v152, v152, v152 row_ror:4 row_mask:0xf bank_mask:0xf
  v_add_f32_dpp v153, v153, v153 row_ror:4 row_mask:0xf bank_mask:0xf
  s_nop 0
  v_add_f32_dpp v152, v152, v152 row_ror:2 row_mask:0xf bank_mask:0xf
  v_add_f32_dpp v153, v153, v153 row_ror:2 row_mask:0xf bank_mask:0xf
  s_nop 0
  v_add_f32_dpp v152, v152, v152 row_ror:1 row_mask:0xf bank_mask:0xf
  v_add_f32_dpp v153, v153, v153 row_ror:1 row_mask:0xf bank_mask:0xf
  v_mov_b32 v154, v152
  v_mov_b32 v155, v153
  s_nop 0
  v_permlane16_swap_b32 v152, v154
  v_permlane16_swap_b32 v153, v155
  v_add_f32 v152, v152, v154
  v_add_f32 v153, v153, v155
  v_mul_f32 v10, 0xb7000000, v152
  v_mul_f32 v2, 0x37000000, v153
  v_fma_f32 v2, -v10, v10, v2
  v_max_f32 v2, 0, v2
  v_add_f32 v2, 0x3727c5ac, v2
  v_rsq_f32 v8, v2
  v_lshlrev_b32 v164, 16, v52
  v_and_b32 v165, s20, v52
  v_lshlrev_b32 v166, 16, v53
  v_and_b32 v167, s20, v53
  v_lshlrev_b32 v168, 16, v54
  v_and_b32 v169, s20, v54
  v_lshlrev_b32 v170, 16, v55
  v_and_b32 v171, s20, v55
  v_lshlrev_b32 v180, 16, v60
  v_and_b32 v181, s20, v60
  v_lshlrev_b32 v182, 16, v61
  v_and_b32 v183, s20, v61
  v_lshlrev_b32 v184, 16, v62
  v_and_b32 v185, s20, v62
  v_lshlrev_b32 v186, 16, v63
  v_and_b32 v187, s20, v63
  v_pk_mul_f32 v[164:165], v[164:165], v[8:9] op_sel_hi:[1,0]
  v_pk_mul_f32 v[166:167], v[166:167], v[8:9] op_sel_hi:[1,0]
  v_pk_mul_f32 v[168:169], v[168:169], v[8:9] op_sel_hi:[1,0]
  v_pk_mul_f32 v[170:171], v[170:171], v[8:9] op_sel_hi:[1,0]
  v_pk_fma_f32 v[180:181], v[164:165], v[10:11], v[180:181] op_sel_hi:[1,0,1]
  v_pk_fma_f32 v[182:183], v[166:167], v[10:11], v[182:183] op_sel_hi:[1,0,1]
  v_pk_fma_f32 v[184:185], v[168:169], v[10:11], v[184:185] op_sel_hi:[1,0,1]
  v_pk_fma_f32 v[186:187], v[170:171], v[10:11], v[186:187] op_sel_hi:[1,0,1]
  v_lshlrev_b32 v196, 16, v18
  v_and_b32 v197, s20, v18
  v_lshlrev_b32 v198, 16, v19
  v_and_b32 v199, s20, v19
  v_lshlrev_b32 v200, 16, v20
  v_and_b32 v201, s20, v20
  v_lshlrev_b32 v202, 16, v21
  v_and_b32 v203, s20, v21
  v_pk_fma_f32 v[196:197], v[196:197], v[164:165], v[180:181]
  v_pk_fma_f32 v[198:199], v[198:199], v[166:167], v[182:183]
  v_pk_fma_f32 v[200:201], v[200:201], v[168:169], v[184:185]
  v_pk_fma_f32 v[202:203], v[202:203], v[170:171], v[186:187]
  v_pk_mul_f32 v[204:205], v[196:197], s[16:17]
  v_pk_mul_f32 v[206:207], v[198:199], s[16:17]
  v_pk_mul_f32 v[208:209], v[200:201], s[16:17]
  v_pk_mul_f32 v[210:211], v[202:203], s[16:17]
  v_exp_f32 v204, v204
  v_exp_f32 v205, v205
  v_exp_f32 v206, v206
  v_exp_f32 v207, v207
  v_exp_f32 v208, v208
  v_exp_f32 v209, v209
  v_exp_f32 v210, v210
  v_exp_f32 v211, v211
  v_pk_add_f32 v[204:205], v[204:205], s[18:19]
  v_pk_add_f32 v[206:207], v[206:207], s[18:19]
  v_pk_add_f32 v[208:209], v[208:209], s[18:19]
  v_pk_add_f32 v[210:211], v[210:211], s[18:19]
  v_rcp_f32 v204, v204
  v_rcp_f32 v205, v205
  v_rcp_f32 v206, v206
  v_rcp_f32 v207, v207
  v_rcp_f32 v208, v208
  v_rcp_f32 v209, v209
  v_rcp_f32 v210, v210
  v_rcp_f32 v211, v211
  v_pk_mul_f32 v[196:197], v[196:197], v[204:205]
  v_pk_mul_f32 v[198:199], v[198:199], v[206:207]
  v_pk_mul_f32 v[200:201], v[200:201], v[208:209]
  v_pk_mul_f32 v[202:203], v[202:203], v[210:211]
  v_cvt_pk_bf16_f32 v212, v196, v197
  v_cvt_pk_bf16_f32 v213, v198, v199
  v_cvt_pk_bf16_f32 v214, v200, v201
  v_cvt_pk_bf16_f32 v215, v202, v203
  v_cndmask_b32 v212, 0, v212, s[24:25]
  v_cndmask_b32 v213, 0, v213, s[24:25]
  v_cndmask_b32 v214, 0, v214, s[24:25]
  v_cndmask_b32 v215, 0, v215, s[24:25]
  ds_write_b128 v110, v[212:215] offset:0
  v_lshlrev_b32 v196, 16, v22
  v_and_b32 v197, s20, v22
  v_lshlrev_b32 v198, 16, v23
  v_and_b32 v199, s20, v23
  v_lshlrev_b32 v200, 16, v24
  v_and_b32 v201, s20, v24
  v_lshlrev_b32 v202, 16, v25
  v_and_b32 v203, s20, v25
  v_pk_fma_f32 v[196:197], v[196:197], v[164:165], v[180:181]
  v_pk_fma_f32 v[198:199], v[198:199], v[166:167], v[182:183]
  v_pk_fma_f32 v[200:201], v[200:201], v[168:169], v[184:185]
  v_pk_fma_f32 v[202:203], v[202:203], v[170:171], v[186:187]
  v_pk_mul_f32 v[204:205], v[196:197], s[16:17]
  v_pk_mul_f32 v[206:207], v[198:199], s[16:17]
  v_pk_mul_f32 v[208:209], v[200:201], s[16:17]
  v_pk_mul_f32 v[210:211], v[202:203], s[16:17]
  v_exp_f32 v204, v204
  v_exp_f32 v205, v205
  v_exp_f32 v206, v206
  v_exp_f32 v207, v207
  v_exp_f32 v208, v208
  v_exp_f32 v209, v209
  v_exp_f32 v210, v210
  v_exp_f32 v211, v211
  v_pk_add_f32 v[204:205], v[204:205], s[18:19]
  v_pk_add_f32 v[206:207], v[206:207], s[18:19]
  v_pk_add_f32 v[208:209], v[208:209], s[18:19]
  v_pk_add_f32 v[210:211], v[210:211], s[18:19]
  v_rcp_f32 v204, v204
  v_rcp_f32 v205, v205
  v_rcp_f32 v206, v206
  v_rcp_f32 v207, v207
  v_rcp_f32 v208, v208
  v_rcp_f32 v209, v209
  v_rcp_f32 v210, v210
  v_rcp_f32 v211, v211
  v_pk_mul_f32 v[196:197], v[196:197], v[204:205]
  v_pk_mul_f32 v[198:199], v[198:199], v[206:207]
  v_pk_mul_f32 v[200:201], v[200:201], v[208:209]
  v_pk_mul_f32 v[202:203], v[202:203], v[210:211]
  v_cvt_pk_bf16_f32 v212, v196, v197
  v_cvt_pk_bf16_f32 v213, v198, v199
  v_cvt_pk_bf16_f32 v214, v200, v201
  v_cvt_pk_bf16_f32 v215, v202, v203
  v_cndmask_b32 v212, 0, v212, s[26:27]
  v_cndmask_b32 v213, 0, v213, s[26:27]
  v_cndmask_b32 v214, 0, v214, s[26:27]
  v_cndmask_b32 v215, 0, v215, s[26:27]
  ds_write_b128 v111, v[212:215] offset:0
  s_mov_b32 s82, 65536
  s_cmp_lg_u32 s4, 1
  s_cbranch_scc1 F_FLAG
  s_nop 7
  s_nop 3
F_POLLJ:
  buffer_load_dwordx4 v[160:163], v115, s[12:15], 0 offen sc0 sc1
  s_waitcnt vmcnt(0)
  v_cmp_eq_u64 vcc, s[64:65], v[160:161]
  v_cmp_eq_u64 s[22:23], s[64:65], v[162:163]
  s_sub_u32 s82, s82, 1
  s_cbranch_scc1 F_SETF
  s_and_b64 vcc, vcc, s[22:23]
  s_cmp_eq_u64 vcc, -1
  s_cbranch_scc0 F_POLLJ
F_SETF:
  v_mov_b32 v160, s64
  v_mov_b32 v161, s65
  ds_write_b64 v101, v[160:161] offset:8
  s_branch F_GOJ
F_FLAG:
  ds_read_b64 v[160:161], v101 offset:8
  s_waitcnt lgkmcnt(0)
  v_cmp_eq_u64 vcc, s[64:65], v[160:161]
  s_sub_u32 s82, s82, 1
  s_cbranch_scc1 F_GOJ
  s_cmp_eq_u64 vcc, -1
  s_cbranch_scc0 F_FLAG
F_GOJ:
  s_waitcnt lgkmcnt(0)
  buffer_load_dwordx4 v[68:71], v125, s[12:15], 0 offen offset:0
  buffer_load_dwordx4 v[72:75], v125, s[12:15], 0 offen offset:1024
  buffer_load_dwordx4 v[76:79], v125, s[12:15], 0 offen offset:2048
  buffer_load_dwordx4 v[80:83], v125, s[12:15], 0 offen offset:3072
  buffer_load_dwordx4 v[84:87], v5, s[12:15], 0 offen
  v_lshlrev_b32 v196, 16, v26
  v_and_b32 v197, s20, v26
  v_lshlrev_b32 v198, 16, v27
  v_and_b32 v199, s20, v27
  v_lshlrev_b32 v200, 16, v28
  v_and_b32 v201, s20, v28
  v_lshlrev_b32 v202, 16, v29
  v_and_b32 v203, s20, v29
  v_pk_fma_f32 v[196:197], v[196:197], v[164:165], v[180:181]
  v_pk_fma_f32 v[198:199], v[198:199], v[166:167], v[182:183]
  v_pk_fma_f32 v[200:201], v[200:201], v[168:169], v[184:185]
  v_pk_fma_f32 v[202:203], v[202:203], v[170:171], v[186:187]
  v_pk_mul_f32 v[204:205], v[196:197], s[16:17]
  v_pk_mul_f32 v[206:207], v[198:199], s[16:17]
  v_pk_mul_f32 v[208:209], v[200:201], s[16:17]
  v_pk_mul_f32 v[210:211], v[202:203], s[16:17]
  v_exp_f32 v204, v204
  s_mov_b32 s83, 2097152
  buffer_load_dwordx4 a[0:3], v117, s[12:15], s83 offen offset:0
  v_exp_f32 v205, v205
  v_exp_f32 v206, v206
  v_exp_f32 v207, v207
  v_exp_f32 v208, v208
  v_exp_f32 v209, v209
  buffer_load_dwordx4 a[4:7], v117, s[12:15], s83 offen offset:1024
  v_exp_f32 v210, v210
  v_exp_f32 v211, v211
  v_pk_add_f32 v[204:205], v[204:205], s[18:19]
  v_pk_add_f32 v[206:207], v[206:207], s[18:19]
  v_pk_add_f32 v[208:209], v[208:209], s[18:19]
  v_pk_add_f32 v[210:211], v[210:211], s[18:19]
  v_rcp_f32 v204, v204
  v_rcp_f32 v205, v205
  buffer_load_dwordx4 a[8:11], v117, s[12:15], s83 offen offset:2048
  v_rcp_f32 v206, v206
  v_rcp_f32 v207, v207
  v_rcp_f32 v208, v208
  v_rcp_f32 v209, v209
  v_rcp_f32 v210, v210
  buffer_load_dwordx4 a[12:15], v117, s[12:15], s83 offen offset:3072
  v_rcp_f32 v211, v211
  v_pk_mul_f32 v[196:197], v[196:197], v[204:205]
  v_pk_mul_f32 v[198:199], v[198:199], v[206:207]
  v_pk_mul_f32 v[200:201], v[200:201], v[208:209]
  v_pk_mul_f32 v[202:203], v[202:203], v[210:211]
  v_cvt_pk_bf16_f32 v212, v196, v197
  v_cvt_pk_bf16_f32 v213, v198, v199
  v_cvt_pk_bf16_f32 v214, v200, v201
  v_cvt_pk_bf16_f32 v215, v202, v203
  v_cndmask_b32 v212, 0, v212, s[28:29]
  v_cndmask_b32 v213, 0, v213, s[28:29]
  v_cndmask_b32 v214, 0, v214, s[28:29]
  v_cndmask_b32 v215, 0, v215, s[28:29]
  ds_write_b128 v112, v[212:215] offset:0
  s_waitcnt lgkmcnt(0)
  s_barrier
  ds_read_b128 v[216:219], v118 offset:0
  s_mov_b32 s83, 2101248
  buffer_load_dwordx4 a[16:19], v117, s[12:15], s83 offen offset:0
  ds_read_b128 v[220:223], v119 offset:0
  ds_read_b128 v[224:227], v118 offset:272
  ds_read_b128 v[228:231], v119 offset:272
  v_lshlrev_b32 v172, 16, v56
  v_and_b32 v173, s20, v56
  v_lshlrev_b32 v174, 16, v57
  v_and_b32 v175, s20, v57
  v_lshlrev_b32 v176, 16, v58
  v_and_b32 v177, s20, v58
  v_lshlrev_b32 v178, 16, v59
  v_and_b32 v179, s20, v59
  v_lshlrev_b32 v188, 16, v64
  v_and_b32 v189, s20, v64
  v_lshlrev_b32 v190, 16, v65
  v_and_b32 v191, s20, v65
  v_lshlrev_b32 v192, 16, v66
  v_and_b32 v193, s20, v66
  v_lshlrev_b32 v194, 16, v67
  v_and_b32 v195, s20, v67
  v_pk_mul_f32 v[172:173], v[172:173], v[8:9] op_sel_hi:[1,0]
  v_pk_mul_f32 v[174:175], v[174:175], v[8:9] op_sel_hi:[1,0]
  v_pk_mul_f32 v[176:177], v[176:177], v[8:9] op_sel_hi:[1,0]
  v_pk_mul_f32 v[178:179], v[178:179], v[8:9] op_sel_hi:[1,0]
  v_pk_fma_f32 v[188:189], v[172:173], v[10:11], v[188:189] op_sel_hi:[1,0,1]
  v_pk_fma_f32 v[190:191], v[174:175], v[10:11], v[190:191] op_sel_hi:[1,0,1]
  v_pk_fma_f32 v[192:193], v[176:177], v[10:11], v[192:193] op_sel_hi:[1,0,1]
  v_pk_fma_f32 v[194:195], v[178:179], v[10:11], v[194:195] op_sel_hi:[1,0,1]
  v_lshlrev_b32 v196, 16, v30
  v_and_b32 v197, s20, v30
  v_lshlrev_b32 v198, 16, v31
  v_and_b32 v199, s20, v31
  v_lshlrev_b32 v200, 16, v32
  v_and_b32 v201, s20, v32
  v_lshlrev_b32 v202, 16, v33
  v_and_b32 v203, s20, v33
  v_pk_fma_f32 v[196:197], v[196:197], v[172:173], v[188:189]
  v_pk_fma_f32 v[198:199], v[198:199], v[174:175], v[190:191]
  v_pk_fma_f32 v[200:201], v[200:201], v[176:177], v[192:193]
  v_pk_fma_f32 v[202:203], v[202:203], v[178:179], v[194:195]
  v_pk_mul_f32 v[204:205], v[196:197], s[16:17]
  v_pk_mul_f32 v[206:207], v[198:199], s[16:17]
  v_pk_mul_f32 v[208:209], v[200:201], s[16:17]
  v_pk_mul_f32 v[210:211], v[202:203], s[16:17]
  v_exp_f32 v204, v204
  v_exp_f32 v205, v205
  v_exp_f32 v206, v206
  v_exp_f32 v207, v207
  v_exp_f32 v208, v208
  v_exp_f32 v209, v209
  v_exp_f32 v210, v210
  v_exp_f32 v211, v211
  v_pk_add_f32 v[204:205], v[204:205], s[18:19]
  v_pk_add_f32 v[206:207], v[206:207], s[18:19]
  v_pk_add_f32 v[208:209], v[208:209], s[18:19]
  v_pk_add_f32 v[210:211], v[210:211], s[18:19]
  v_rcp_f32 v204, v204
  v_rcp_f32 v205, v205
  v_rcp_f32 v206, v206
  v_rcp_f32 v207, v207
  v_rcp_f32 v208, v208
  v_rcp_f32 v209, v209
  buffer_load_dwordx4 v[160:163], v116, s[12:15], 0 offen sc0 sc1
  ds_read_b128 v[232:235], v118 offset:544
  ds_read_b128 v[236:239], v119 offset:544
  s_waitcnt vmcnt(5) lgkmcnt(4)
  v_mfma_f32_32x32x16_bf16 v[68:83], a[0:3], v[216:219], 0
  buffer_load_dwordx4 a[20:23], v117, s[12:15], s83 offen offset:1024
  v_rcp_f32 v210, v210
  v_mfma_f32_32x32x16_bf16 v[84:99], a[0:3], v[220:223], 0
  v_rcp_f32 v211, v211
  ds_read_b128 v[240:243], v118 offset:3488
  ds_read_b128 v[244:247], v119 offset:3488
  s_waitcnt vmcnt(5) lgkmcnt(4)
  v_mfma_f32_32x32x16_bf16 v[68:83], a[4:7], v[224:227], v[68:83]
  buffer_load_dwordx4 a[24:27], v117, s[12:15], s83 offen offset:2048
  v_pk_mul_f32 v[196:197], v[196:197], v[204:205]
  v_pk_mul_f32 v[198:199], v[198:199], v[206:207]
  v_pk_mul_f32 v[200:201], v[200:201], v[208:209]
  v_mfma_f32_32x32x16_bf16 v[84:99], a[4:7], v[228:231], v[84:99]
  v_pk_mul_f32 v[202:203], v[202:203], v[210:211]
  v_cvt_pk_bf16_f32 v212, v196, v197
  v_cvt_pk_bf16_f32 v213, v198, v199
  ds_read_b128 v[216:219], v118 offset:3760
  ds_read_b128 v[220:223], v119 offset:3760
  s_waitcnt vmcnt(5) lgkmcnt(4)
  v_mfma_f32_32x32x16_bf16 v[68:83], a[8:11], v[232:235], v[68:83]
  buffer_load_dwordx4 a[28:31], v117, s[12:15], s83 offen offset:3072
  v_cvt_pk_bf16_f32 v214, v200, v201
  v_cvt_pk_bf16_f32 v215, v202, v203
  v_cndmask_b32 v212, 0, v212, s[24:25]
  v_cndmask_b32 v213, 0, v213, s[24:25]
  v_mfma_f32_32x32x16_bf16 v[84:99], a[8:11], v[236:239], v[84:99]
  v_cndmask_b32 v214, 0, v214, s[24:25]
  v_cndmask_b32 v215, 0, v215, s[24:25]
  ds_write_b128 v110, v[212:215] offset:32
  ds_read_b128 v[224:227], v118 offset:4032
  ds_read_b128 v[228:231], v119 offset:4032
  s_waitcnt vmcnt(5) lgkmcnt(5)
  v_mfma_f32_32x32x16_bf16 v[68:83], a[12:15], v[240:243], v[68:83]
  s_mov_b32 s83, 2105344
  buffer_load_dwordx4 a[32:35], v117, s[12:15], s83 offen offset:0
  v_lshlrev_b32 v196, 16, v34
  v_and_b32 v197, s20, v34
  v_lshlrev_b32 v198, 16, v35
  v_mfma_f32_32x32x16_bf16 v[84:99], a[12:15], v[244:247], v[84:99]
  v_and_b32 v199, s20, v35
  v_lshlrev_b32 v200, 16, v36
  v_and_b32 v201, s20, v36
  ds_read_b128 v[232:235], v118 offset:6976
  ds_read_b128 v[236:239], v119 offset:6976
  s_mov_b32 s83, 2113536
  buffer_load_dwordx4 a[36:39], v117, s[12:15], s83 offen offset:2048
  s_waitcnt vmcnt(6) lgkmcnt(5)
  v_mfma_f32_32x32x16_bf16 v[68:83], a[16:19], v[216:219], v[68:83]
  v_lshlrev_b32 v202, 16, v37
  v_and_b32 v203, s20, v37
  v_pk_fma_f32 v[196:197], v[196:197], v[172:173], v[188:189]
  v_pk_fma_f32 v[198:199], v[198:199], v[174:175], v[190:191]
  v_mfma_f32_32x32x16_bf16 v[84:99], a[16:19], v[220:223], v[84:99]
  v_pk_fma_f32 v[200:201], v[200:201], v[176:177], v[192:193]
  v_pk_fma_f32 v[202:203], v[202:203], v[178:179], v[194:195]
  v_pk_mul_f32 v[204:205], v[196:197], s[16:17]
  s_waitcnt vmcnt(5)
  s_mov_b32 s82, 65536
  s_branch F_CHKE
F_POLLE:
  buffer_load_dwordx4 v[160:163], v116, s[12:15], 0 offen sc0 sc1
  s_waitcnt vmcnt(0)
F_CHKE:
  v_cmp_eq_u64 vcc, s[64:65], v[160:161]
  v_cmp_eq_u64 s[22:23], s[64:65], v[162:163]
  s_sub_u32 s82, s82, 1
  s_cbranch_scc1 F_GOE
  s_and_b64 vcc, vcc, s[22:23]
  s_cmp_eq_u64 vcc, -1
  s_cbranch_scc0 F_POLLE
F_GOE:
  buffer_load_dwordx4 v[128:131], v126, s[12:15], 0 offen offset:0
  buffer_load_dwordx4 v[132:135], v126, s[12:15], 0 offen offset:32
  buffer_load_dwordx4 v[136:139], v126, s[12:15], 0 offen offset:64
  buffer_load_dwordx4 v[140:143], v126, s[12:15], 0 offen offset:96
  ds_read_b128 v[240:243], v118 offset:7248
  buffer_load_dwordx4 a[40:43], v117, s[12:15], s83 offen offset:3072
  ds_read_b128 v[244:247], v119 offset:7248
  s_waitcnt vmcnt(9) lgkmcnt(4)
  v_mfma_f32_32x32x16_bf16 v[68:83], a[20:23], v[224:227], v[68:83]
  v_pk_mul_f32 v[206:207], v[198:199], s[16:17]
  v_pk_mul_f32 v[208:209], v[200:201], s[16:17]
  v_pk_mul_f32 v[210:211], v[202:203], s[16:17]
  v_exp_f32 v204, v204
  v_mfma_f32_32x32x16_bf16 v[84:99], a[20:23], v[228:231], v[84:99]
  s_mov_b32 s83, 2117632
  buffer_load_dwordx4 a[44:47], v117, s[12:15], s83 offen offset:0
  ds_read_b128 v[216:219], v118 offset:7520
  ds_read_b128 v[220:223], v119 offset:7520
  s_waitcnt vmcnt(9) lgkmcnt(4)
  v_mfma_f32_32x32x16_bf16 v[68:83], a[24:27], v[232:235], v[68:83]
  v_exp_f32 v205, v205
  v_mfma_f32_32x32x16_bf16 v[84:99], a[24:27], v[236:239], v[84:99]
  buffer_load_dwordx4 a[48:51], v117, s[12:15], s83 offen offset:1024
  v_exp_f32 v206, v206
  ds_read_b128 v[224:227], v118 offset:64
  ds_read_b128 v[228:231], v119 offset:64
  s_waitcnt vmcnt(9) lgkmcnt(4)
  v_mfma_f32_32x32x16_bf16 v[68:83], a[28:31], v[240:243], v[68:83]
  v_exp_f32 v207, v207
  v_mfma_f32_32x32x16_bf16 v[84:99], a[28:31], v[244:247], v[84:99]
  buffer_load_dwordx4 a[52:55], v117, s[12:15], s83 offen offset:2048
  v_exp_f32 v208, v208
  ds_read_b128 v[232:235], v118 offset:336
  ds_read_b128 v[236:239], v119 offset:336
  s_waitcnt vmcnt(9) lgkmcnt(4)
  v_mfma_f32_32x32x16_bf16 v[68:83], a[32:35], v[216:219], v[68:83]
  v_exp_f32 v209, v209
  v_mfma_f32_32x32x16_bf16 v[84:99], a[32:35], v[220:223], v[84:99]
  buffer_load_dwordx4 a[56:59], v117, s[12:15], s83 offen offset:3072
  v_exp_f32 v210, v210
  ds_read_b128 v[240:243], v118 offset:608
  ds_read_b128 v[244:247], v119 offset:608
  s_waitcnt vmcnt(9) lgkmcnt(4)
  v_mfma_f32_32x32x16_bf16 v[68:83], a[36:39], v[224:227], v[68:83]
  s_mov_b32 s83, 2121728
  buffer_load_dwordx4 a[60:63], v117, s[12:15], s83 offen offset:0
  v_exp_f32 v211, v211
  v_mfma_f32_32x32x16_bf16 v[84:99], a[36:39], v[228:231], v[84:99]
  ds_read_b128 v[216:219], v118 offset:3552
  ds_read_b128 v[220:223], v119 offset:3552
  s_waitcnt vmcnt(5) lgkmcnt(4)
  v_mfma_f32_32x32x16_bf16 v[68:83], a[40:43], v[232:235], v[68:83]
  buffer_load_dwordx4 a[64:67], v117, s[12:15], s83 offen offset:1024
  v_pk_add_f32 v[204:205], v[204:205], s[18:19]
  v_pk_add_f32 v[206:207], v[206:207], s[18:19]
  v_pk_add_f32 v[208:209], v[208:209], s[18:19]
  v_pk_add_f32 v[210:211], v[210:211], s[18:19]
  v_mfma_f32_32x32x16_bf16 v[84:99], a[40:43], v[236:239], v[84:99]
  v_rcp_f32 v204, v204
  ds_read_b128 v[224:227], v118 offset:3824
  ds_read_b128 v[228:231], v119 offset:3824
  s_waitcnt vmcnt(5) lgkmcnt(4)
  v_mfma_f32_32x32x16_bf16 v[68:83], a[44:47], v[240:243], v[68:83]
  buffer_load_dwordx4 a[68:71], v117, s[12:15], s83 offen offset:2048
  v_rcp_f32 v205, v205
  v_mfma_f32_32x32x16_bf16 v[84:99], a[44:47], v[244:247], v[84:99]
  v_rcp_f32 v206, v206
  ds_read_b128 v[232:235], v118 offset:4096
  ds_read_b128 v[236:239], v119 offset:4096
  s_waitcnt vmcnt(5) lgkmcnt(4)
  v_mfma_f32_32x32x16_bf16 v[68:83], a[48:51], v[216:219], v[68:83]
  s_mov_b32 s83, 2134016
  buffer_load_dwordx4 a[72:75], v117, s[12:15], s83 offen offset:0
  v_rcp_f32 v207, v207
  v_mfma_f32_32x32x16_bf16 v[84:99], a[48:51], v[220:223], v[84:99]
  v_rcp_f32 v208, v208
  ds_read_b128 v[240:243], v118 offset:7040
  ds_read_b128 v[244:247], v119 offset:7040
  buffer_load_dwordx4 a[76:79], v117, s[12:15], s83 offen offset:1024
  s_waitcnt vmcnt(6) lgkmcnt(4)
  v_mfma_f32_32x32x16_bf16 v[68:83], a[52:55], v[224:227], v[68:83]
  v_rcp_f32 v209, v209
  v_mfma_f32_32x32x16_bf16 v[84:99], a[52:55], v[228:231], v[84:99]
  ds_read_b128 v[216:219], v118 offset:7312
  buffer_load_dwordx4 a[80:83], v117, s[12:15], s83 offen offset:2048
  ds_read_b128 v[220:223], v119 offset:7312
  s_waitcnt vmcnt(6) lgkmcnt(4)
  v_mfma_f32_32x32x16_bf16 v[68:83], a[56:59], v[232:235], v[68:83]
  v_rcp_f32 v210, v210
  v_mfma_f32_32x32x16_bf16 v[84:99], a[56:59], v[236:239], v[84:99]
  buffer_load_dwordx4 a[84:87], v117, s[12:15], s83 offen offset:3072
  v_rcp_f32 v211, v211
  ds_read_b128 v[224:227], v118 offset:7584
  ds_read_b128 v[228:231], v119 offset:7584
  s_waitcnt vmcnt(6) lgkmcnt(4)
  v_mfma_f32_32x32x16_bf16 v[68:83], a[60:63], v[240:243], v[68:83]
  v_pk_mul_f32 v[196:197], v[196:197], v[204:205]
  v_pk_mul_f32 v[198:199], v[198:199], v[206:207]
  v_pk_mul_f32 v[200:201], v[200:201], v[208:209]
  v_mfma_f32_32x32x16_bf16 v[84:99], a[60:63], v[244:247], v[84:99]
  s_mov_b32 s83, 2138112
  buffer_load_dwordx4 a[88:91], v117, s[12:15], s83 offen offset:0
  v_pk_mul_f32 v[202:203], v[202:203], v[210:211]
  v_cvt_pk_bf16_f32 v212, v196, v197
  v_cvt_pk_bf16_f32 v213, v198, v199
  ds_read_b128 v[232:235], v118 offset:128
  ds_read_b128 v[236:239], v119 offset:128
  s_waitcnt vmcnt(6) lgkmcnt(4)
  v_mfma_f32_32x32x16_bf16 v[68:83], a[64:67], v[216:219], v[68:83]
  v_cvt_pk_bf16_f32 v214, v200, v201
  v_cvt_pk_bf16_f32 v215, v202, v203
  v_cndmask_b32 v212, 0, v212, s[26:27]
  v_cndmask_b32 v213, 0, v213, s[26:27]
  v_mfma_f32_32x32x16_bf16 v[84:99], a[64:67], v[220:223], v[84:99]
  buffer_load_dwordx4 a[92:95], v117, s[12:15], s83 offen offset:1024
  v_cndmask_b32 v214, 0, v214, s[26:27]
  v_cndmask_b32 v215, 0, v215, s[26:27]
  ds_write_b128 v111, v[212:215] offset:32
  ds_read_b128 v[240:243], v118 offset:400
  ds_read_b128 v[244:247], v119 offset:400
  s_waitcnt vmcnt(6) lgkmcnt(5)
  v_mfma_f32_32x32x16_bf16 v[68:83], a[68:71], v[224:227], v[68:83]
  v_lshlrev_b32 v196, 16, v38
  v_and_b32 v197, s20, v38
  v_lshlrev_b32 v198, 16, v39
  v_mfma_f32_32x32x16_bf16 v[84:99], a[68:71], v[228:231], v[84:99]
  buffer_load_dwordx4 a[96:99], v117, s[12:15], s83 offen offset:2048
  v_and_b32 v199, s20, v39
  v_lshlrev_b32 v200, 16, v40
  v_and_b32 v201, s20, v40
  ds_read_b128 v[216:219], v118 offset:672
  ds_read_b128 v[220:223], v119 offset:672
  s_waitcnt vmcnt(6) lgkmcnt(5)
  v_mfma_f32_32x32x16_bf16 v[68:83], a[72:75], v[232:235], v[68:83]
  buffer_load_dwordx4 a[100:103], v117, s[12:15], s83 offen offset:3072
  v_lshlrev_b32 v202, 16, v41
  v_and_b32 v203, s20, v41
  v_pk_fma_f32 v[196:197], v[196:197], v[172:173], v[188:189]
  v_pk_fma_f32 v[198:199], v[198:199], v[174:175], v[190:191]
  v_mfma_f32_32x32x16_bf16 v[84:99], a[72:75], v[236:239], v[84:99]
  v_pk_fma_f32 v[200:201], v[200:201], v[176:177], v[192:193]
  v_pk_fma_f32 v[202:203], v[202:203], v[178:179], v[194:195]
  v_pk_mul_f32 v[204:205], v[196:197], s[16:17]
  ds_read_b128 v[224:227], v118 offset:3616
  ds_read_b128 v[228:231], v119 offset:3616
  s_waitcnt vmcnt(6) lgkmcnt(4)
  v_mfma_f32_32x32x16_bf16 v[68:83], a[76:79], v[240:243], v[68:83]
  s_mov_b32 s83, 2142208
  buffer_load_dwordx4 a[104:107], v117, s[12:15], s83 offen offset:0
  v_pk_mul_f32 v[206:207], v[198:199], s[16:17]
  v_pk_mul_f32 v[208:209], v[200:201], s[16:17]
  v_pk_mul_f32 v[210:211], v[202:203], s[16:17]
  v_exp_f32 v204, v204
  v_mfma_f32_32x32x16_bf16 v[84:99], a[76:79], v[244:247], v[84:99]
  ds_read_b128 v[232:235], v118 offset:3888
  ds_read_b128 v[236:239], v119 offset:3888
  s_waitcnt vmcnt(6) lgkmcnt(4)
  v_mfma_f32_32x32x16_bf16 v[68:83], a[80:83], v[216:219], v[68:83]
  s_mov_b32 s83, 2150400
  buffer_load_dwordx4 a[108:111], v117, s[12:15], s83 offen offset:2048
  v_exp_f32 v205, v205
  v_mfma_f32_32x32x16_bf16 v[84:99], a[80:83], v[220:223], v[84:99]
  v_exp_f32 v206, v206
  ds_read_b128 v[240:243], v118 offset:4160
  ds_read_b128 v[244:247], v119 offset:4160
  s_waitcnt vmcnt(6) lgkmcnt(4)
  v_mfma_f32_32x32x16_bf16 v[68:83], a[84:87], v[224:227], v[68:83]
  buffer_load_dwordx4 a[112:115], v117, s[12:15], s83 offen offset:3072
  v_exp_f32 v207, v207
  v_mfma_f32_32x32x16_bf16 v[84:99], a[84:87], v[228:231], v[84:99]
  v_exp_f32 v208, v208
  ds_read_b128 v[216:219], v118 offset:7104
  ds_read_b128 v[220:223], v119 offset:7104
  s_mov_b32 s83, 2154496
  buffer_load_dwordx4 a[116:119], v117, s[12:15], s83 offen offset:0
  s_waitcnt vmcnt(7) lgkmcnt(4)
  v_mfma_f32_32x32x16_bf16 v[68:83], a[88:91], v[232:235], v[68:83]
  v_exp_f32 v209, v209
  v_mfma_f32_32x32x16_bf16 v[84:99], a[88:91], v[236:239], v[84:99]
  v_exp_f32 v210, v210
  ds_read_b128 v[224:227], v118 offset:7376
  buffer_load_dwordx4 a[120:123], v117, s[12:15], s83 offen offset:1024
  ds_read_b128 v[228:231], v119 offset:7376
  s_waitcnt vmcnt(7) lgkmcnt(4)
  v_mfma_f32_32x32x16_bf16 v[68:83], a[92:95], v[240:243], v[68:83]
  v_exp_f32 v211, v211
  v_mfma_f32_32x32x16_bf16 v[84:99], a[92:95], v[244:247], v[84:99]
  buffer_load_dwordx4 a[124:127], v117, s[12:15], s83 offen offset:2048
  ds_read_b128 v[232:235], v118 offset:7648
  ds_read_b128 v[236:239], v119 offset:7648
  s_waitcnt vmcnt(7) lgkmcnt(4)
  v_mfma_f32_32x32x16_bf16 v[68:83], a[96:99], v[216:219], v[68:83]
  v_pk_add_f32 v[204:205], v[204:205], s[18:19]
  v_pk_add_f32 v[206:207], v[206:207], s[18:19]
  v_pk_add_f32 v[208:209], v[208:209], s[18:19]
  v_pk_add_f32 v[210:211], v[210:211], s[18:19]
  v_mfma_f32_32x32x16_bf16 v[84:99], a[96:99], v[220:223], v[84:99]
  buffer_load_dwordx4 a[128:131], v117, s[12:15], s83 offen offset:3072
  v_rcp_f32 v204, v204
  ds_read_b128 v[240:243], v118 offset:192
  ds_read_b128 v[244:247], v119 offset:192
  s_waitcnt vmcnt(7) lgkmcnt(4)
  v_mfma_f32_32x32x16_bf16 v[68:83], a[100:103], v[224:227], v[68:83]
  v_rcp_f32 v205, v205
  v_mfma_f32_32x32x16_bf16 v[84:99], a[100:103], v[228:231], v[84:99]
  s_mov_b32 s83, 2158592
  buffer_load_dwordx4 a[132:135], v117, s[12:15], s83 offen offset:0
  v_rcp_f32 v206, v206
  ds_read_b128 v[216:219], v118 offset:464
  ds_read_b128 v[220:223], v119 offset:464
  s_waitcnt vmcnt(7) lgkmcnt(4)
  v_mfma_f32_32x32x16_bf16 v[68:83], a[104:107], v[232:235], v[68:83]
  v_rcp_f32 v207, v207
  v_mfma_f32_32x32x16_bf16 v[84:99], a[104:107], v[236:239], v[84:99]
  buffer_load_dwordx4 a[136:139], v117, s[12:15], s83 offen offset:1024
  v_rcp_f32 v208, v208
  ds_read_b128 v[224:227], v118 offset:736
  ds_read_b128 v[228:231], v119 offset:736
  s_waitcnt vmcnt(7) lgkmcnt(4)
  v_mfma_f32_32x32x16_bf16 v[68:83], a[108:111], v[240:243], v[68:83]
  buffer_load_dwordx4 a[140:143], v117, s[12:15], s83 offen offset:2048
  v_rcp_f32 v209, v209
  v_mfma_f32_32x32x16_bf16 v[84:99], a[108:111], v[244:247], v[84:99]
  ds_read_b128 v[232:235], v118 offset:3680
  ds_read_b128 v[236:239], v119 offset:3680
  s_waitcnt vmcnt(7) lgkmcnt(4)
  v_mfma_f32_32x32x16_bf16 v[68:83], a[112:115], v[216:219], v[68:83]
  s_mov_b32 s83, 2105344
  buffer_load_dwordx4 a[144:147], v117, s[12:15], s83 offen offset:1024
  v_rcp_f32 v210, v210
  v_mfma_f32_32x32x16_bf16 v[84:99], a[112:115], v[220:223], v[84:99]
  v_rcp_f32 v211, v211
  ds_read_b128 v[240:243], v118 offset:3952
  ds_read_b128 v[244:247], v119 offset:3952
  s_waitcnt vmcnt(7) lgkmcnt(4)
  v_mfma_f32_32x32x16_bf16 v[68:83], a[116:119], v[224:227], v[68:83]
  buffer_load_dwordx4 a[148:151], v117, s[12:15], s83 offen offset:2048
  v_pk_mul_f32 v[196:197], v[196:197], v[204:205]
  v_pk_mul_f32 v[198:199], v[198:199], v[206:207]
  v_pk_mul_f32 v[200:201], v[200:201], v[208:209]
  v_mfma_f32_32x32x16_bf16 v[84:99], a[116:119], v[228:231], v[84:99]
  v_pk_mul_f32 v[202:203], v[202:203], v[210:211]
  v_cvt_pk_bf16_f32 v212, v196, v197
  v_cvt_pk_bf16_f32 v213, v198, v199
  ds_read_b128 v[216:219], v118 offset:4224
  ds_read_b128 v[220:223], v119 offset:4224
  s_waitcnt vmcnt(7) lgkmcnt(4)
  v_mfma_f32_32x32x16_bf16 v[68:83], a[120:123], v[232:235], v[68:83]
  buffer_load_dwordx4 a[152:155], v117, s[12:15], s83 offen offset:3072
  v_cvt_pk_bf16_f32 v214, v200, v201
  v_cvt_pk_bf16_f32 v215, v202, v203
  v_cndmask_b32 v212, 0, v212, s[28:29]
  v_cndmask_b32 v213, 0, v213, s[28:29]
  v_mfma_f32_32x32x16_bf16 v[84:99], a[120:123], v[236:239], v[84:99]
  v_cndmask_b32 v214, 0, v214, s[28:29]
  v_cndmask_b32 v215, 0, v215, s[28:29]
  ds_write_b128 v112, v[212:215] offset:32
  ds_read_b128 v[224:227], v118 offset:7168
  ds_read_b128 v[228:231], v119 offset:7168
  s_mov_b32 s83, 2109440
  buffer_load_dwordx4 a[156:159], v117, s[12:15], s83 offen offset:0
  s_waitcnt vmcnt(8) lgkmcnt(5)
  v_mfma_f32_32x32x16_bf16 v[68:83], a[124:127], v[240:243], v[68:83]
  v_mfma_f32_32x32x16_bf16 v[84:99], a[124:127], v[244:247], v[84:99]
  ds_read_b128 v[232:235], v118 offset:7440
  buffer_load_dwordx4 a[160:163], v117, s[12:15], s83 offen offset:1024
  ds_read_b128 v[236:239], v119 offset:7440
  s_waitcnt vmcnt(8) lgkmcnt(5)
  v_mfma_f32_32x32x16_bf16 v[68:83], a[128:131], v[216:219], v[68:83]
  v_mfma_f32_32x32x16_bf16 v[84:99], a[128:131], v[220:223], v[84:99]
  buffer_load_dwordx4 a[164:167], v117, s[12:15], s83 offen offset:2048
  ds_read_b128 v[240:243], v118 offset:7712
  ds_read_b128 v[244:247], v119 offset:7712
  s_waitcnt vmcnt(8) lgkmcnt(4)
  v_mfma_f32_32x32x16_bf16 v[68:83], a[132:135], v[224:227], v[68:83]
  v_mfma_f32_32x32x16_bf16 v[84:99], a[132:135], v[228:231], v[84:99]
  buffer_load_dwordx4 a[168:171], v117, s[12:15], s83 offen offset:3072
  s_waitcnt lgkmcnt(0)
  s_barrier
  ds_read_b128 v[216:219], v118 offset:32
  ds_read_b128 v[220:223], v119 offset:32
  s_waitcnt vmcnt(8)
  v_mfma_f32_32x32x16_bf16 v[68:83], a[136:139], v[232:235], v[68:83]
  v_mfma_f32_32x32x16_bf16 v[84:99], a[136:139], v[236:239], v[84:99]
  s_mov_b32 s83, 2113536
  buffer_load_dwordx4 a[172:175], v117, s[12:15], s83 offen offset:0
  ds_read_b128 v[224:227], v118 offset:304
  ds_read_b128 v[228:231], v119 offset:304
  s_waitcnt vmcnt(8)
  v_mfma_f32_32x32x16_bf16 v[68:83], a[140:143], v[240:243], v[68:83]
  buffer_load_dwordx4 a[176:179], v117, s[12:15], s83 offen offset:1024
  v_mfma_f32_32x32x16_bf16 v[84:99], a[140:143], v[244:247], v[84:99]
  ds_read_b128 v[232:235], v118 offset:576
  ds_read_b128 v[236:239], v119 offset:576
  s_waitcnt vmcnt(8) lgkmcnt(4)
  v_mfma_f32_32x32x16_bf16 v[68:83], a[144:147], v[216:219], v[68:83]
  s_mov_b32 s83, 2121728
  buffer_load_dwordx4 a[180:183], v117, s[12:15], s83 offen offset:3072
  v_mfma_f32_32x32x16_bf16 v[84:99], a[144:147], v[220:223], v[84:99]
  ds_read_b128 v[240:243], v118 offset:3520
  ds_read_b128 v[244:247], v119 offset:3520
  s_waitcnt vmcnt(8) lgkmcnt(4)
  v_mfma_f32_32x32x16_bf16 v[68:83], a[148:151], v[224:227], v[68:83]
  s_mov_b32 s83, 2125824
  buffer_load_dwordx4 a[184:187], v117, s[12:15], s83 offen offset:0
  v_mfma_f32_32x32x16_bf16 v[84:99], a[148:151], v[228:231], v[84:99]
  ds_read_b128 v[216:219], v118 offset:3792
  ds_read_b128 v[220:223], v119 offset:3792
  s_waitcnt vmcnt(8) lgkmcnt(4)
  v_mfma_f32_32x32x16_bf16 v[68:83], a[152:155], v[232:235], v[68:83]
  buffer_load_dwordx4 a[188:191], v117, s[12:15], s83 offen offset:1024
  v_mfma_f32_32x32x16_bf16 v[84:99], a[152:155], v[236:239], v[84:99]
  ds_read_b128 v[224:227], v118 offset:4064
  ds_read_b128 v[228:231], v119 offset:4064
  buffer_load_dwordx4 a[192:195], v117, s[12:15], s83 offen offset:2048
  s_waitcnt vmcnt(9) lgkmcnt(4)
  v_mfma_f32_32x32x16_bf16 v[68:83], a[156:159], v[240:243], v[68:83]
  v_mfma_f32_32x32x16_bf16 v[84:99], a[156:159], v[244:247], v[84:99]
  ds_read_b128 v[232:235], v118 offset:7008
  buffer_load_dwordx4 a[196:199], v117, s[12:15], s83 offen offset:3072
  ds_read_b128 v[236:239], v119 offset:7008
  s_waitcnt vmcnt(9) lgkmcnt(4)
  v_mfma_f32_32x32x16_bf16 v[68:83], a[160:163], v[216:219], v[68:83]
  v_mfma_f32_32x32x16_bf16 v[84:99], a[160:163], v[220:223], v[84:99]
  s_mov_b32 s83, 2129920
  buffer_load_dwordx4 a[200:203], v117, s[12:15], s83 offen offset:0
  ds_read_b128 v[240:243], v118 offset:7280
  ds_read_b128 v[244:247], v119 offset:7280
  s_waitcnt vmcnt(9) lgkmcnt(4)
  v_mfma_f32_32x32x16_bf16 v[68:83], a[164:167], v[224:227], v[68:83]
  v_mfma_f32_32x32x16_bf16 v[84:99], a[164:167], v[228:231], v[84:99]
  buffer_load_dwordx4 a[204:207], v117, s[12:15], s83 offen offset:1024
  ds_read_b128 v[216:219], v118 offset:7552
  ds_read_b128 v[220:223], v119 offset:7552
  s_waitcnt vmcnt(9) lgkmcnt(4)
  v_mfma_f32_32x32x16_bf16 v[68:83], a[168:171], v[232:235], v[68:83]
  v_mfma_f32_32x32x16_bf16 v[84:99], a[168:171], v[236:239], v[84:99]
  buffer_load_dwordx4 a[208:211], v117, s[12:15], s83 offen offset:2048
  ds_read_b128 v[224:227], v118 offset:96
  ds_read_b128 v[228:231], v119 offset:96
  s_waitcnt vmcnt(9) lgkmcnt(4)
  v_mfma_f32_32x32x16_bf16 v[68:83], a[172:175], v[240:243], v[68:83]
  v_mfma_f32_32x32x16_bf16 v[84:99], a[172:175], v[244:247], v[84:99]
  buffer_load_dwordx4 a[212:215], v117, s[12:15], s83 offen offset:3072
  ds_read_b128 v[232:235], v118 offset:368
  ds_read_b128 v[236:239], v119 offset:368
  s_waitcnt vmcnt(9) lgkmcnt(4)
  v_mfma_f32_32x32x16_bf16 v[68:83], a[176:179], v[216:219], v[68:83]
  s_mov_b32 s83, 2142208
  buffer_load_dwordx4 a[216:219], v117, s[12:15], s83 offen offset:1024
  v_mfma_f32_32x32x16_bf16 v[84:99], a[176:179], v[220:223], v[84:99]
  ds_read_b128 v[240:243], v118 offset:640
  ds_read_b128 v[244:247], v119 offset:640
  s_waitcnt vmcnt(9) lgkmcnt(4)
  v_mfma_f32_32x32x16_bf16 v[68:83], a[180:183], v[224:227], v[68:83]
  buffer_load_dwordx4 a[220:223], v117, s[12:15], s83 offen offset:2048
  v_mfma_f32_32x32x16_bf16 v[84:99], a[180:183], v[228:231], v[84:99]
  ds_read_b128 v[216:219], v118 offset:3584
  ds_read_b128 v[220:223], v119 offset:3584
  s_waitcnt vmcnt(9) lgkmcnt(4)
  v_mfma_f32_32x32x16_bf16 v[68:83], a[184:187], v[232:235], v[68:83]
  buffer_load_dwordx4 a[224:227], v117, s[12:15], s83 offen offset:3072
  v_mfma_f32_32x32x16_bf16 v[84:99], a[184:187], v[236:239], v[84:99]
  ds_read_b128 v[224:227], v118 offset:3856
  ds_read_b128 v[228:231], v119 offset:3856
  s_waitcnt vmcnt(9) lgkmcnt(4)
  v_mfma_f32_32x32x16_bf16 v[68:83], a[188:191], v[240:243], v[68:83]
  s_mov_b32 s83, 2146304
  buffer_load_dwordx4 a[228:231], v117, s[12:15], s83 offen offset:0
  v_mfma_f32_32x32x16_bf16 v[84:99], a[188:191], v[244:247], v[84:99]
  ds_read_b128 v[232:235], v118 offset:4128
  ds_read_b128 v[236:239], v119 offset:4128
  buffer_load_dwordx4 a[232:235], v117, s[12:15], s83 offen offset:1024
  s_waitcnt vmcnt(10) lgkmcnt(4)
  v_mfma_f32_32x32x16_bf16 v[68:83], a[192:195], v[216:219], v[68:83]
  v_mfma_f32_32x32x16_bf16 v[84:99], a[192:195], v[220:223], v[84:99]
  ds_read_b128 v[240:243], v118 offset:7072
  buffer_load_dwordx4 a[236:239], v117, s[12:15], s83 offen offset:2048
  ds_read_b128 v[244:247], v119 offset:7072
  s_waitcnt vmcnt(10) lgkmcnt(4)
  v_mfma_f32_32x32x16_bf16 v[68:83], a[196:199], v[224:227], v[68:83]
  v_mfma_f32_32x32x16_bf16 v[84:99], a[196:199], v[228:231], v[84:99]
  buffer_load_dwordx4 a[240:243], v117, s[12:15], s83 offen offset:3072
  ds_read_b128 v[216:219], v118 offset:7344
  ds_read_b128 v[220:223], v119 offset:7344
  s_waitcnt vmcnt(10) lgkmcnt(4)
  v_mfma_f32_32x32x16_bf16 v[68:83], a[200:203], v[232:235], v[68:83]
  v_mfma_f32_32x32x16_bf16 v[84:99], a[200:203], v[236:239], v[84:99]
  s_mov_b32 s83, 2150400
  buffer_load_dwordx4 a[244:247], v117, s[12:15], s83 offen offset:0
  ds_read_b128 v[224:227], v118 offset:7616
  ds_read_b128 v[228:231], v119 offset:7616
  s_waitcnt vmcnt(10) lgkmcnt(4)
  v_mfma_f32_32x32x16_bf16 v[68:83], a[204:207], v[240:243], v[68:83]
  v_mfma_f32_32x32x16_bf16 v[84:99], a[204:207], v[244:247], v[84:99]
  buffer_load_dwordx4 a[248:251], v117, s[12:15], s83 offen offset:1024
  ds_read_b128 v[232:235], v118 offset:160
  ds_read_b128 v[236:239], v119 offset:160
  s_waitcnt vmcnt(10) lgkmcnt(4)
  v_mfma_f32_32x32x16_bf16 v[68:83], a[208:211], v[216:219], v[68:83]
  v_mfma_f32_32x32x16_bf16 v[84:99], a[208:211], v[220:223], v[84:99]
  s_mov_b32 s83, 2158592
  buffer_load_dwordx4 a[252:255], v117, s[12:15], s83 offen offset:3072
  ds_read_b128 v[240:243], v118 offset:432
  ds_read_b128 v[244:247], v119 offset:432
  s_waitcnt vmcnt(10) lgkmcnt(4)
  v_mfma_f32_32x32x16_bf16 v[68:83], a[212:215], v[224:227], v[68:83]
  s_mov_b32 s83, 2162688
  buffer_load_dwordx4 a[0:3], v117, s[12:15], s83 offen offset:0
  v_mfma_f32_32x32x16_bf16 v[84:99], a[212:215], v[228:231], v[84:99]
  ds_read_b128 v[216:219], v118 offset:704
  ds_read_b128 v[220:223], v119 offset:704
  s_waitcnt vmcnt(10) lgkmcnt(4)
  v_mfma_f32_32x32x16_bf16 v[68:83], a[216:219], v[232:235], v[68:83]
  buffer_load_dwordx4 a[4:7], v117, s[12:15], s83 offen offset:1024
  v_mfma_f32_32x32x16_bf16 v[84:99], a[216:219], v[236:239], v[84:99]
  ds_read_b128 v[224:227], v118 offset:3648
  ds_read_b128 v[228:231], v119 offset:3648
  s_waitcnt vmcnt(10) lgkmcnt(4)
  v_mfma_f32_32x32x16_bf16 v[68:83], a[220:223], v[240:243], v[68:83]
  buffer_load_dwordx4 a[8:11], v117, s[12:15], s83 offen offset:2048
  v_mfma_f32_32x32x16_bf16 v[84:99], a[220:223], v[244:247], v[84:99]
  ds_read_b128 v[232:235], v118 offset:3920
  ds_read_b128 v[236:239], v119 offset:3920
  s_waitcnt vmcnt(10) lgkmcnt(4)
  v_mfma_f32_32x32x16_bf16 v[68:83], a[224:227], v[216:219], v[68:83]
  buffer_load_dwordx4 a[12:15], v117, s[12:15], s83 offen offset:3072
  v_mfma_f32_32x32x16_bf16 v[84:99], a[224:227], v[220:223], v[84:99]
  ds_read_b128 v[240:243], v118 offset:4192
  ds_read_b128 v[244:247], v119 offset:4192
  s_mov_b32 s83, 2166784
  buffer_load_dwordx4 a[16:19], v117, s[12:15], s83 offen offset:0
  s_waitcnt vmcnt(11) lgkmcnt(4)
  v_mfma_f32_32x32x16_bf16 v[68:83], a[228:231], v[224:227], v[68:83]
  v_mfma_f32_32x32x16_bf16 v[84:99], a[228:231], v[228:231], v[84:99]
  ds_read_b128 v[216:219], v118 offset:7136
  buffer_load_dwordx4 a[20:23], v117, s[12:15], s83 offen offset:1024
  ds_read_b128 v[220:223], v119 offset:7136
  s_waitcnt vmcnt(11) lgkmcnt(4)
  v_mfma_f32_32x32x16_bf16 v[68:83], a[232:235], v[232:235], v[68:83]
  v_mfma_f32_32x32x16_bf16 v[84:99], a[232:235], v[236:239], v[84:99]
  buffer_load_dwordx4 a[24:27], v117, s[12:15], s83 offen offset:2048
  ds_read_b128 v[224:227], v118 offset:7408
  ds_read_b128 v[228:231], v119 offset:7408
  s_waitcnt vmcnt(11) lgkmcnt(4)
  v_mfma_f32_32x32x16_bf16 v[68:83], a[236:239], v[240:243], v[68:83]
  v_mfma_f32_32x32x16_bf16 v[84:99], a[236:239], v[244:247], v[84:99]
  buffer_load_dwordx4 a[28:31], v117, s[12:15], s83 offen offset:3072
  ds_read_b128 v[232:235], v118 offset:7680
  ds_read_b128 v[236:239], v119 offset:7680
  s_waitcnt vmcnt(11) lgkmcnt(4)
  v_mfma_f32_32x32x16_bf16 v[68:83], a[240:243], v[216:219], v[68:83]
  v_mfma_f32_32x32x16_bf16 v[84:99], a[240:243], v[220:223], v[84:99]
  global_load_dwordx2 v[102:103], v127, s[48:49] offset:0
  ds_read_b128 v[240:243], v118 offset:224
  ds_read_b128 v[244:247], v119 offset:224
  s_waitcnt vmcnt(11) lgkmcnt(4)
  v_mfma_f32_32x32x16_bf16 v[68:83], a[244:247], v[224:227], v[68:83]
  v_mfma_f32_32x32x16_bf16 v[84:99], a[244:247], v[228:231], v[84:99]
  global_load_dwordx2 v[104:105], v127, s[48:49] offset:16
  ds_read_b128 v[216:219], v118 offset:496
  ds_read_b128 v[220:223], v119 offset:496
  s_waitcnt vmcnt(11) lgkmcnt(4)
  v_mfma_f32_32x32x16_bf16 v[68:83], a[248:251], v[232:235], v[68:83]
  global_load_dwordx2 v[106:107], v127, s[48:49] offset:32
  v_mfma_f32_32x32x16_bf16 v[84:99], a[248:251], v[236:239], v[84:99]
  ds_read_b128 v[224:227], v118 offset:768
  ds_read_b128 v[228:231], v119 offset:768
  s_waitcnt vmcnt(11) lgkmcnt(4)
  v_mfma_f32_32x32x16_bf16 v[68:83], a[252:255], v[240:243], v[68:83]
  global_load_dwordx2 v[108:109], v127, s[48:49] offset:48
  v_mfma_f32_32x32x16_bf16 v[84:99], a[252:255], v[244:247], v[84:99]
  ds_read_b128 v[232:235], v118 offset:3712
  ds_read_b128 v[236:239], v119 offset:3712
  s_waitcnt vmcnt(11) lgkmcnt(4)
  v_mfma_f32_32x32x16_bf16 v[68:83], a[0:3], v[216:219], v[68:83]
  global_load_dwordx2 v[144:145], v127, s[50:51] offset:0
  v_mfma_f32_32x32x16_bf16 v[84:99], a[0:3], v[220:223], v[84:99]
  ds_read_b128 v[240:243], v118 offset:3984
  ds_read_b128 v[244:247], v119 offset:3984
  s_waitcnt vmcnt(11) lgkmcnt(4)
  v_mfma_f32_32x32x16_bf16 v[68:83], a[4:7], v[224:227], v[68:83]
  global_load_dwordx2 v[146:147], v127, s[50:51] offset:16
  v_mfma_f32_32x32x16_bf16 v[84:99], a[4:7], v[228:231], v[84:99]
  ds_read_b128 v[216:219], v118 offset:4256
  ds_read_b128 v[220:223], v119 offset:4256
  global_load_dwordx2 v[148:149], v127, s[50:51] offset:32
  s_waitcnt vmcnt(12) lgkmcnt(4)
  v_mfma_f32_32x32x16_bf16 v[68:83], a[8:11], v[232:235], v[68:83]
  v_mfma_f32_32x32x16_bf16 v[84:99], a[8:11], v[236:239], v[84:99]
  ds_read_b128 v[224:227], v118 offset:7200
  global_load_dwordx2 v[150:151], v127, s[50:51] offset:48
  ds_read_b128 v[228:231], v119 offset:7200
  s_waitcnt vmcnt(12) lgkmcnt(4)
  v_mfma_f32_32x32x16_bf16 v[68:83], a[12:15], v[240:243], v[68:83]
  v_mfma_f32_32x32x16_bf16 v[84:99], a[12:15], v[244:247], v[84:99]
  ds_read_b128 v[232:235], v118 offset:7472
  ds_read_b128 v[236:239], v119 offset:7472
  s_waitcnt vmcnt(11) lgkmcnt(4)
  v_mfma_f32_32x32x16_bf16 v[68:83], a[16:19], v[216:219], v[68:83]
  v_mfma_f32_32x32x16_bf16 v[84:99], a[16:19], v[220:223], v[84:99]
  ds_read_b128 v[240:243], v118 offset:7744
  ds_read_b128 v[244:247], v119 offset:7744
  s_waitcnt vmcnt(10) lgkmcnt(4)
  v_mfma_f32_32x32x16_bf16 v[68:83], a[20:23], v[224:227], v[68:83]
  v_mfma_f32_32x32x16_bf16 v[84:99], a[20:23], v[228:231], v[84:99]
  s_waitcnt vmcnt(9) lgkmcnt(2)
  v_mfma_f32_32x32x16_bf16 v[68:83], a[24:27], v[232:235], v[68:83]
  v_mfma_f32_32x32x16_bf16 v[84:99], a[24:27], v[236:239], v[84:99]
  s_waitcnt vmcnt(8) lgkmcnt(0)
  v_mfma_f32_32x32x16_bf16 v[68:83], a[28:31], v[240:243], v[68:83]
  v_mfma_f32_32x32x16_bf16 v[84:99], a[28:31], v[244:247], v[84:99]
  s_mov_b32 s83, 2392064
  buffer_load_dwordx4 a[32:35], v117, s[12:15], s83 offen offset:0
  buffer_load_dwordx4 a[36:39], v117, s[12:15], s83 offen offset:1024
  buffer_load_dwordx4 a[40:43], v117, s[12:15], s83 offen offset:2048
  s_nop 6
  v_pk_add_f32 v[68:69], v[68:69], v[128:129]
  v_pk_add_f32 v[70:71], v[70:71], v[130:131]
  v_pk_add_f32 v[72:73], v[72:73], v[132:133]
  v_pk_add_f32 v[74:75], v[74:75], v[134:135]
  v_pk_add_f32 v[76:77], v[76:77], v[136:137]
  v_pk_add_f32 v[78:79], v[78:79], v[138:139]
  v_pk_add_f32 v[80:81], v[80:81], v[140:141]
  v_pk_add_f32 v[82:83], v[82:83], v[142:143]
  v_pk_add_f32 v[84:85], v[84:85], v[128:129]
  v_pk_add_f32 v[86:87], v[86:87], v[130:131]
  v_pk_add_f32 v[88:89], v[88:89], v[132:133]
  v_pk_add_f32 v[90:91], v[90:91], v[134:135]
  v_pk_add_f32 v[92:93], v[92:93], v[136:137]
  v_pk_add_f32 v[94:95], v[94:95], v[138:139]
  v_pk_add_f32 v[96:97], v[96:97], v[140:141]
  v_pk_add_f32 v[98:99], v[98:99], v[142:143]
  v_pk_add_f32 v[18:19], v[68:69], v[70:71]
  v_pk_mul_f32 v[20:21], v[68:69], v[68:69]
  v_pk_add_f32 v[22:23], v[84:85], v[86:87]
  v_pk_mul_f32 v[24:25], v[84:85], v[84:85]
  v_pk_fma_f32 v[20:21], v[70:71], v[70:71], v[20:21]
  v_pk_fma_f32 v[24:25], v[86:87], v[86:87], v[24:25]
  v_pk_add_f32 v[18:19], v[18:19], v[72:73]
  v_pk_fma_f32 v[20:21], v[72:73], v[72:73], v[20:21]
  v_pk_add_f32 v[22:23], v[22:23], v[88:89]
  v_pk_fma_f32 v[24:25], v[88:89], v[88:89], v[24:25]
  v_pk_add_f32 v[18:19], v[18:19], v[74:75]
  v_pk_fma_f32 v[20:21], v[74:75], v[74:75], v[20:21]
  v_pk_add_f32 v[22:23], v[22:23], v[90:91]
  v_pk_fma_f32 v[24:25], v[90:91], v[90:91], v[24:25]
  v_pk_add_f32 v[18:19], v[18:19], v[76:77]
  v_pk_fma_f32 v[20:21], v[76:77], v[76:77], v[20:21]
  v_pk_add_f32 v[22:23], v[22:23], v[92:93]
  v_pk_fma_f32 v[24:25], v[92:93], v[92:93], v[24:25]
  v_pk_add_f32 v[18:19], v[18:19], v[78:79]
  v_pk_fma_f32 v[20:21], v[78:79], v[78:79], v[20:21]
  v_pk_add_f32 v[22:23], v[22:23], v[94:95]
  v_pk_fma_f32 v[24:25], v[94:95], v[94:95], v[24:25]
  v_pk_add_f32 v[18:19], v[18:19], v[80:81]
  v_pk_fma_f32 v[20:21], v[80:81], v[80:81], v[20:21]
  v_pk_add_f32 v[22:23], v[22:23], v[96:97]
  v_pk_fma_f32 v[24:25], v[96:97], v[96:97], v[24:25]
  v_pk_add_f32 v[18:19], v[18:19], v[82:83]
  v_pk_fma_f32 v[20:21], v[82:83], v[82:83], v[20:21]
  v_pk_add_f32 v[22:23], v[22:23], v[98:99]
  v_pk_fma_f32 v[24:25], v[98:99], v[98:99], v[24:25]
  v_add_f32 v18, v18, v19
  v_add_f32 v20, v20, v21
  v_add_f32 v22, v22, v23
  v_add_f32 v24, v24, v25
  v_cndmask_b32 v18, 0, v18, s[72:73]
  v_cndmask_b32 v20, 0, v20, s[72:73]
  v_cndmask_b32 v22, 0, v22, s[74:75]
  v_cndmask_b32 v24, 0, v24, s[74:75]
  v_add_f32 v18, v18, v22
  v_add_f32 v19, v20, v24
  s_nop 0
  v_add_f32_dpp v18, v18, v18 row_ror:8 row_mask:0xf bank_mask:0xf
  v_add_f32_dpp v19, v19, v19 row_ror:8 row_mask:0xf bank_mask:0xf
  s_nop 0
  v_add_f32_dpp v18, v18, v18 row_ror:4 row_mask:0xf bank_mask:0xf
  v_add_f32_dpp v19, v19, v19 row_ror:4 row_mask:0xf bank_mask:0xf
  s_nop 0
  v_add_f32_dpp v18, v18, v18 row_ror:2 row_mask:0xf bank_mask:0xf
  v_add_f32_dpp v19, v19, v19 row_ror:2 row_mask:0xf bank_mask:0xf
  s_nop 0
  v_add_f32_dpp v18, v18, v18 row_ror:1 row_mask:0xf bank_mask:0xf
  v_add_f32_dpp v19, v19, v19 row_ror:1 row_mask:0xf bank_mask:0xf
  v_mov_b32 v20, v18
  v_mov_b32 v21, v19
  s_nop 0
  v_permlane16_swap_b32 v18, v20
  v_permlane16_swap_b32 v19, v21
  v_add_f32 v18, v18, v20
  v_add_f32 v19, v19, v21
  v_mov_b32 v20, v18
  v_mov_b32 v21, v19
  s_nop 0
  v_permlane32_swap_b32 v18, v20
  v_permlane32_swap_b32 v19, v21
  v_add_f32 v18, v18, v20
  v_add_f32 v19, v19, v21
  v_cmp_eq_u32 vcc, -1, v19
  v_mov_b32 v20, 0x7fc00000
  s_nop 0
  v_cndmask_b32 v19, v19, v20, vcc
  s_waitcnt vmcnt(3)
  s_mov_b64 exec, 1
  buffer_store_dwordx2 v[18:19], v124, s[12:15], 0 offen sc0 sc1
  s_mov_b64 exec, -1
  buffer_load_dwordx4 a[44:47], v117, s[12:15], s83 offen offset:3072
  s_mov_b32 s83, 2396160
  buffer_load_dwordx4 a[48:51], v117, s[12:15], s83 offen offset:0
  buffer_load_dwordx4 a[52:55], v117, s[12:15], s83 offen offset:1024
  buffer_load_dwordx4 a[56:59], v117, s[12:15], s83 offen offset:2048
  buffer_load_dwordx4 a[60:63], v117, s[12:15], s83 offen offset:3072
  s_mov_b32 s83, 2400256
  buffer_load_dwordx4 a[64:67], v117, s[12:15], s83 offen offset:0
  s_mov_b32 s83, 2408448
  buffer_load_dwordx4 a[68:71], v117, s[12:15], s83 offen offset:2048
  buffer_load_dwordx4 a[72:75], v117, s[12:15], s83 offen offset:3072
  s_mov_b32 s83, 2412544
  buffer_load_dwordx4 a[76:79], v117, s[12:15], s83 offen offset:0
  buffer_load_dwordx4 a[80:83], v117, s[12:15], s83 offen offset:1024
  buffer_load_dwordx4 a[84:87], v117, s[12:15], s83 offen offset:2048
  buffer_load_dwordx4 a[88:91], v117, s[12:15], s83 offen offset:3072
  s_mov_b32 s83, 2416640
  buffer_load_dwordx4 a[92:95], v117, s[12:15], s83 offen offset:0
  buffer_load_dwordx4 a[96:99], v117, s[12:15], s83 offen offset:1024
  buffer_load_dwordx4 a[100:103], v117, s[12:15], s83 offen offset:2048
  s_mov_b32 s83, 2428928
  buffer_load_dwordx4 a[104:107], v117, s[12:15], s83 offen offset:0
  buffer_load_dwordx4 a[108:111], v117, s[12:15], s83 offen offset:1024
  buffer_load_dwordx4 a[112:115], v117, s[12:15], s83 offen offset:2048
  buffer_load_dwordx4 a[116:119], v117, s[12:15], s83 offen offset:3072
  s_mov_b32 s83, 2433024
  buffer_load_dwordx4 a[120:123], v117, s[12:15], s83 offen offset:0
  buffer_load_dwordx4 a[124:127], v117, s[12:15], s83 offen offset:1024
  buffer_load_dwordx4 a[128:131], v117, s[12:15], s83 offen offset:2048
  buffer_load_dwordx4 a[132:135], v117, s[12:15], s83 offen offset:3072
  s_mov_b32 s83, 2437120
  buffer_load_dwordx4 a[136:139], v117, s[12:15], s83 offen offset:0
  v_lshlrev_b32 v26, 16, v102
  v_and_b32 v27, s20, v102
  v_lshlrev_b32 v28, 16, v103
  v_and_b32 v29, s20, v103
  v_lshlrev_b32 v30, 16, v104
  v_and_b32 v31, s20, v104
  v_lshlrev_b32 v32, 16, v105
  v_and_b32 v33, s20, v105
  v_lshlrev_b32 v34, 16, v106
  v_and_b32 v35, s20, v106
  v_lshlrev_b32 v36, 16, v107
  v_and_b32 v37, s20, v107
  v_lshlrev_b32 v38, 16, v108
  v_and_b32 v39, s20, v108
  v_lshlrev_b32 v40, 16, v109
  v_and_b32 v41, s20, v109
  v_lshlrev_b32 v52, 16, v144
  v_and_b32 v53, s20, v144
  v_lshlrev_b32 v54, 16, v145
  v_and_b32 v55, s20, v145
  v_lshlrev_b32 v56, 16, v146
  v_and_b32 v57, s20, v146
  v_lshlrev_b32 v58, 16, v147
  v_and_b32 v59, s20, v147
  v_lshlrev_b32 v60, 16, v148
  v_and_b32 v61, s20, v148
  v_lshlrev_b32 v62, 16, v149
  v_and_b32 v63, s20, v149
  v_lshlrev_b32 v64, 16, v150
  v_and_b32 v65, s20, v150
  v_lshlrev_b32 v66, 16, v151
  v_and_b32 v67, s20, v151
  v_lshlrev_b32 v128, 16, v44
  v_and_b32 v129, s20, v44
  v_lshlrev_b32 v130, 16, v45
  v_and_b32 v131, s20, v45
  v_lshlrev_b32 v132, 16, v46
  v_and_b32 v133, s20, v46
  v_lshlrev_b32 v134, 16, v47
  v_and_b32 v135, s20, v47
  v_lshlrev_b32 v136, 16, v48
  v_and_b32 v137, s20, v48
  v_lshlrev_b32 v138, 16, v49
  v_and_b32 v139, s20, v49
  v_lshlrev_b32 v140, 16, v50
  v_and_b32 v141, s20, v50
  v_lshlrev_b32 v142, 16, v51
  v_and_b32 v143, s20, v51
  s_mov_b32 s82, 65536
  buffer_load_dwordx4 v[152:155], v123, s[12:15], 0 offen sc0 sc1
  s_mov_b32 s83, 2445312
  buffer_load_dwordx4 a[140:143], v117, s[12:15], s83 offen offset:2048
  buffer_load_dwordx4 a[144:147], v117, s[12:15], s83 offen offset:3072
  s_mov_b32 s83, 2449408
  buffer_load_dwordx4 a[148:151], v117, s[12:15], s83 offen offset:0
  buffer_load_dwordx4 a[152:155], v117, s[12:15], s83 offen offset:1024
  s_waitcnt vmcnt(4)
  s_branch F_CHK2
F_POLL2:
  buffer_load_dwordx4 v[152:155], v123, s[12:15], 0 offen sc0 sc1
  s_waitcnt vmcnt(0)
F_CHK2:
  v_cmp_ne_u32 vcc, -1, v153
  v_cmp_ne_u32 s[22:23], -1, v155
  s_sub_u32 s82, s82, 1
  s_cbranch_scc1 F_GO2
  s_and_b64 vcc, vcc, s[22:23]
  s_cmp_eq_u64 vcc, -1
  s_cbranch_scc0 F_POLL2
F_GO2:
  s_or_b32 s22, s2, s4
  s_cmp_eq_u32 s22, 0
  s_cbranch_scc0 F_NOEP
  v_lshlrev_b32 v13, 5, v1
  v_add_u32 v13, 2713600, v13
  buffer_load_dwordx4 v[102:105], v13, s[12:15], 0 offen sc0 sc1
  buffer_load_dwordx4 v[106:109], v13, s[12:15], 0 offen offset:16 sc0 sc1
F_NOEP:
  v_pk_add_f32 v[152:153], v[152:153], v[154:155]
  s_nop 1
  v_add_f32_dpp v152, v152, v152 row_ror:8 row_mask:0xf bank_mask:0xf
  v_add_f32_dpp v153, v153, v153 row_ror:8 row_mask:0xf bank_mask:0xf
  s_nop 0
  v_add_f32_dpp v152, v152, v152 row_ror:4 row_mask:0xf bank_mask:0xf
  v_add_f32_dpp v153, v153, v153 row_ror:4 row_mask:0xf bank_mask:0xf
  s_nop 0
  v_add_f32_dpp v152, v152, v152 row_ror:2 row_mask:0xf bank_mask:0xf
  v_add_f32_dpp v153, v153, v153 row_ror:2 row_mask:0xf bank_mask:0xf
  s_nop 0
  v_add_f32_dpp v152, v152, v152 row_ror:1 row_mask:0xf bank_mask:0xf
  v_add_f32_dpp v153, v153, v153 row_ror:1 row_mask:0xf bank_mask:0xf
  v_mov_b32 v154, v152
  v_mov_b32 v155, v153
  s_nop 0
  v_permlane16_swap_b32 v152, v154
  v_permlane16_swap_b32 v153, v155
  v_add_f32 v152, v152, v154
  buffer_load_dwordx4 a[156:159], v117, s[12:15], s83 offen offset:2048
  v_add_f32 v153, v153, v155
  v_mov_b32 v154, v152
  v_mov_b32 v155, v153
  s_nop 0
  v_permlane32_swap_b32 v152, v154
  v_permlane32_swap_b32 v153, v155
  v_add_f32 v152, v152, v154
  v_add_f32 v153, v153, v155
  v_mul_f32 v10, 0xb7000000, v152
  v_mul_f32 v2, 0x37000000, v153
  v_fma_f32 v2, -v10, v10, v2
  v_max_f32 v2, 0, v2
  v_add_f32 v2, 0x3727c5ac, v2
  v_rsq_f32 v8, v2
  buffer_load_dwordx4 a[160:163], v117, s[12:15], s83 offen offset:3072
  v_pk_mul_f32 v[26:27], v[26:27], v[8:9] op_sel_hi:[1,0]
  v_pk_mul_f32 v[28:29], v[28:29], v[8:9] op_sel_hi:[1,0]
  v_pk_mul_f32 v[30:31], v[30:31], v[8:9] op_sel_hi:[1,0]
  v_pk_mul_f32 v[32:33], v[32:33], v[8:9] op_sel_hi:[1,0]
  v_pk_mul_f32 v[34:35], v[34:35], v[8:9] op_sel_hi:[1,0]
  v_pk_mul_f32 v[36:37], v[36:37], v[8:9] op_sel_hi:[1,0]
  v_pk_mul_f32 v[38:39], v[38:39], v[8:9] op_sel_hi:[1,0]
  v_pk_mul_f32 v[40:41], v[40:41], v[8:9] op_sel_hi:[1,0]
  v_pk_fma_f32 v[52:53], v[26:27], v[10:11], v[52:53] op_sel_hi:[1,0,1]
  v_pk_fma_f32 v[54:55], v[28:29], v[10:11], v[54:55] op_sel_hi:[1,0,1]
  v_pk_fma_f32 v[56:57], v[30:31], v[10:11], v[56:57] op_sel_hi:[1,0,1]
  v_pk_fma_f32 v[58:59], v[32:33], v[10:11], v[58:59] op_sel_hi:[1,0,1]
  s_mov_b32 s83, 2453504
  buffer_load_dwordx4 a[164:167], v117, s[12:15], s83 offen offset:0
  v_pk_fma_f32 v[60:61], v[34:35], v[10:11], v[60:61] op_sel_hi:[1,0,1]
  v_pk_fma_f32 v[62:63], v[36:37], v[10:11], v[62:63] op_sel_hi:[1,0,1]
  v_pk_fma_f32 v[64:65], v[38:39], v[10:11], v[64:65] op_sel_hi:[1,0,1]
  v_pk_fma_f32 v[66:67], v[40:41], v[10:11], v[66:67] op_sel_hi:[1,0,1]
  v_pk_fma_f32 v[68:69], v[68:69], v[26:27], v[52:53]
  v_pk_fma_f32 v[70:71], v[70:71], v[28:29], v[54:55]
  v_pk_fma_f32 v[72:73], v[72:73], v[30:31], v[56:57]
  v_pk_fma_f32 v[74:75], v[74:75], v[32:33], v[58:59]
  v_pk_mul_f32 v[144:145], v[68:69], s[16:17]
  v_pk_mul_f32 v[146:147], v[70:71], s[16:17]
  v_pk_mul_f32 v[148:149], v[72:73], s[16:17]
  v_pk_mul_f32 v[150:151], v[74:75], s[16:17]
  v_exp_f32 v144, v144
  buffer_load_dwordx4 a[168:171], v117, s[12:15], s83 offen offset:1024
  v_exp_f32 v145, v145
  v_exp_f32 v146, v146
  v_exp_f32 v147, v147
  buffer_load_dwordx4 a[172:175], v117, s[12:15], s83 offen offset:2048
  v_exp_f32 v148, v148
  v_exp_f32 v149, v149
  v_exp_f32 v150, v150
  v_exp_f32 v151, v151
  s_mov_b32 s83, 2400256
  buffer_load_dwordx4 a[176:179], v117, s[12:15], s83 offen offset:1024
  v_pk_add_f32 v[144:145], v[144:145], s[18:19]
  v_pk_add_f32 v[146:147], v[146:147], s[18:19]
  v_pk_add_f32 v[148:149], v[148:149], s[18:19]
  v_pk_add_f32 v[150:151], v[150:151], s[18:19]
  v_rcp_f32 v144, v144
  v_rcp_f32 v145, v145
  buffer_load_dwordx4 a[180:183], v117, s[12:15], s83 offen offset:2048
  v_rcp_f32 v146, v146
  v_rcp_f32 v147, v147
  v_rcp_f32 v148, v148
  v_rcp_f32 v149, v149
  buffer_load_dwordx4 a[184:187], v117, s[12:15], s83 offen offset:3072
  v_rcp_f32 v150, v150
  v_rcp_f32 v151, v151
  v_pk_mul_f32 v[68:69], v[68:69], v[144:145]
  v_pk_mul_f32 v[70:71], v[70:71], v[146:147]
  v_pk_mul_f32 v[72:73], v[72:73], v[148:149]
  v_pk_mul_f32 v[74:75], v[74:75], v[150:151]
  s_mov_b32 s83, 2404352
  buffer_load_dwordx4 a[188:191], v117, s[12:15], s83 offen offset:0
  v_cvt_pk_bf16_f32 v164, v68, v69
  v_cvt_pk_bf16_f32 v165, v70, v71
  v_cvt_pk_bf16_f32 v166, v72, v73
  v_cvt_pk_bf16_f32 v167, v74, v75
  v_cndmask_b32 v164, 0, v164, s[76:77]
  v_cndmask_b32 v165, 0, v165, s[76:77]
  v_cndmask_b32 v166, 0, v166, s[76:77]
  v_cndmask_b32 v167, 0, v167, s[76:77]
  ds_write_b64 v120, v[164:165] offset:0
  ds_write_b64 v120, v[166:167] offset:16
  v_pk_fma_f32 v[84:85], v[84:85], v[26:27], v[52:53]
  v_pk_fma_f32 v[86:87], v[86:87], v[28:29], v[54:55]
  v_pk_fma_f32 v[88:89], v[88:89], v[30:31], v[56:57]
  v_pk_fma_f32 v[90:91], v[90:91], v[32:33], v[58:59]
  v_pk_mul_f32 v[144:145], v[84:85], s[16:17]
  v_pk_mul_f32 v[146:147], v[86:87], s[16:17]
  buffer_load_dwordx4 a[192:195], v117, s[12:15], s83 offen offset:1024
  v_pk_mul_f32 v[148:149], v[88:89], s[16:17]
  v_pk_mul_f32 v[150:151], v[90:91], s[16:17]
  v_exp_f32 v144, v144
  v_exp_f32 v145, v145
  v_exp_f32 v146, v146
  buffer_load_dwordx4 a[196:199], v117, s[12:15], s83 offen offset:2048
  v_exp_f32 v147, v147
  v_exp_f32 v148, v148
  v_exp_f32 v149, v149
  v_exp_f32 v150, v150
  buffer_load_dwordx4 a[200:203], v117, s[12:15], s83 offen offset:3072
  v_exp_f32 v151, v151
  v_pk_add_f32 v[144:145], v[144:145], s[18:19]
  v_pk_add_f32 v[146:147], v[146:147], s[18:19]
  v_pk_add_f32 v[148:149], v[148:149], s[18:19]
  v_pk_add_f32 v[150:151], v[150:151], s[18:19]
  v_rcp_f32 v144, v144
  s_mov_b32 s83, 2408448
  buffer_load_dwordx4 a[204:207], v117, s[12:15], s83 offen offset:0
  v_rcp_f32 v145, v145
  v_rcp_f32 v146, v146
  v_rcp_f32 v147, v147
  v_rcp_f32 v148, v148
  buffer_load_dwordx4 a[208:211], v117, s[12:15], s83 offen offset:1024
  v_rcp_f32 v149, v149
  v_rcp_f32 v150, v150
  v_rcp_f32 v151, v151
  s_mov_b32 s83, 2416640
  buffer_load_dwordx4 a[212:215], v117, s[12:15], s83 offen offset:3072
  v_pk_mul_f32 v[84:85], v[84:85], v[144:145]
  v_pk_mul_f32 v[86:87], v[86:87], v[146:147]
  v_pk_mul_f32 v[88:89], v[88:89], v[148:149]
  v_pk_mul_f32 v[90:91], v[90:91], v[150:151]
  v_cvt_pk_bf16_f32 v168, v84, v85
  v_cvt_pk_bf16_f32 v169, v86, v87
  v_cvt_pk_bf16_f32 v170, v88, v89
  v_cvt_pk_bf16_f32 v171, v90, v91
  v_cndmask_b32 v168, 0, v168, s[78:79]
  v_cndmask_b32 v169, 0, v169, s[78:79]
  v_cndmask_b32 v170, 0, v170, s[78:79]
  v_cndmask_b32 v171, 0, v171, s[78:79]
  s_mov_b64 exec, s[80:81]
  ds_write_b64 v121, v[168:169] offset:0
  ds_write_b64 v121, v[170:171] offset:16
  s_mov_b64 exec, -1
  s_waitcnt lgkmcnt(0)
  s_barrier
  ds_read_b128 v[172:175], v122 offset:0
  s_mov_b32 s83, 2420736
  buffer_load_dwordx4 a[216:219], v117, s[12:15], s83 offen offset:0
  ds_read_b128 v[176:179], v122 offset:272
  ds_read_b128 v[180:183], v122 offset:544
  ds_read_b128 v[184:187], v122 offset:2944
  s_waitcnt lgkmcnt(3)
  v_mfma_f32_32x32x16_bf16 v[128:143], v[172:175], a[32:35], v[128:143]
  buffer_load_dwordx4 a[220:223], v117, s[12:15], s83 offen offset:1024
  v_pk_fma_f32 v[76:77], v[76:77], v[34:35], v[60:61]
  v_pk_fma_f32 v[78:79], v[78:79], v[36:37], v[62:63]
  v_pk_fma_f32 v[80:81], v[80:81], v[38:39], v[64:65]
  v_pk_fma_f32 v[82:83], v[82:83], v[40:41], v[66:67]
  v_pk_mul_f32 v[144:145], v[76:77], s[16:17]
  v_pk_mul_f32 v[146:147], v[78:79], s[16:17]
  ds_read_b128 v[188:191], v122 offset:3216
  s_waitcnt lgkmcnt(3)
  v_mfma_f32_32x32x16_bf16 v[128:143], v[176:179], a[36:39], v[128:143]
  buffer_load_dwordx4 a[224:227], v117, s[12:15], s83 offen offset:2048
  v_pk_mul_f32 v[148:149], v[80:81], s[16:17]
  v_pk_mul_f32 v[150:151], v[82:83], s[16:17]
  v_exp_f32 v144, v144
  ds_read_b128 v[192:195], v122 offset:3488
  s_waitcnt lgkmcnt(3)
  v_mfma_f32_32x32x16_bf16 v[128:143], v[180:183], a[40:43], v[128:143]
  buffer_load_dwordx4 a[228:231], v117, s[12:15], s83 offen offset:3072
  v_exp_f32 v145, v145
  v_exp_f32 v146, v146
  ds_read_b128 v[172:175], v122 offset:5888
  s_waitcnt lgkmcnt(3)
  v_mfma_f32_32x32x16_bf16 v[128:143], v[184:187], a[44:47], v[128:143]
  v_exp_f32 v147, v147
  ds_read_b128 v[176:179], v122 offset:6160
  s_mov_b32 s83, 2424832
  buffer_load_dwordx4 a[232:235], v117, s[12:15], s83 offen offset:0
  s_waitcnt lgkmcnt(3)
  v_mfma_f32_32x32x16_bf16 v[128:143], v[188:191], a[48:51], v[128:143]
  v_exp_f32 v148, v148
  v_exp_f32 v149, v149
  ds_read_b128 v[180:183], v122 offset:6432
  s_waitcnt lgkmcnt(3)
  v_mfma_f32_32x32x16_bf16 v[128:143], v[192:195], a[52:55], v[128:143]
  buffer_load_dwordx4 a[236:239], v117, s[12:15], s83 offen offset:1024
  v_exp_f32 v150, v150
  ds_read_b128 v[184:187], v122 offset:64
  s_waitcnt lgkmcnt(3)
  v_mfma_f32_32x32x16_bf16 v[128:143], v[172:175], a[56:59], v[128:143]
  buffer_load_dwordx4 a[240:243], v117, s[12:15], s83 offen offset:2048
  v_exp_f32 v151, v151
  v_pk_add_f32 v[144:145], v[144:145], s[18:19]
  v_pk_add_f32 v[146:147], v[146:147], s[18:19]
  ds_read_b128 v[188:191], v122 offset:336
  s_waitcnt lgkmcnt(3)
  v_mfma_f32_32x32x16_bf16 v[128:143], v[176:179], a[60:63], v[128:143]
  buffer_load_dwordx4 a[244:247], v117, s[12:15], s83 offen offset:3072
  v_pk_add_f32 v[148:149], v[148:149], s[18:19]
  v_pk_add_f32 v[150:151], v[150:151], s[18:19]
  v_rcp_f32 v144, v144
  ds_read_b128 v[192:195], v122 offset:608
  s_waitcnt lgkmcnt(3)
  v_mfma_f32_32x32x16_bf16 v[128:143], v[180:183], a[64:67], v[128:143]
  s_mov_b32 s83, 2437120
  buffer_load_dwordx4 a[248:251], v117, s[12:15], s83 offen offset:1024
  v_rcp_f32 v145, v145
  v_rcp_f32 v146, v146
  ds_read_b128 v[172:175], v122 offset:3008
  s_waitcnt lgkmcnt(3)
  v_mfma_f32_32x32x16_bf16 v[128:143], v[184:187], a[68:71], v[128:143]
  v_rcp_f32 v147, v147
  ds_read_b128 v[176:179], v122 offset:3280
  buffer_load_dwordx4 a[252:255], v117, s[12:15], s83 offen offset:2048
  s_waitcnt lgkmcnt(3)
  v_mfma_f32_32x32x16_bf16 v[128:143], v[188:191], a[72:75], v[128:143]
  v_rcp_f32 v148, v148
  v_rcp_f32 v149, v149
  ds_read_b128 v[180:183], v122 offset:3552
  s_waitcnt lgkmcnt(3)
  v_mfma_f32_32x32x16_bf16 v[128:143], v[192:195], a[76:79], v[128:143]
  buffer_load_dwordx4 a[0:3], v117, s[12:15], s83 offen offset:3072
  v_rcp_f32 v150, v150
  ds_read_b128 v[184:187], v122 offset:5952
  s_waitcnt lgkmcnt(3)
  v_mfma_f32_32x32x16_bf16 v[128:143], v[172:175], a[80:83], v[128:143]
  s_mov_b32 s83, 2441216
  buffer_load_dwordx4 a[4:7], v117, s[12:15], s83 offen offset:0
  v_rcp_f32 v151, v151
  v_pk_mul_f32 v[76:77], v[76:77], v[144:145]
  v_pk_mul_f32 v[78:79], v[78:79], v[146:147]
  ds_read_b128 v[188:191], v122 offset:6224
  s_waitcnt lgkmcnt(3)
  v_mfma_f32_32x32x16_bf16 v[128:143], v[176:179], a[84:87], v[128:143]
  buffer_load_dwordx4 a[8:11], v117, s[12:15], s83 offen offset:1024
  v_pk_mul_f32 v[80:81], v[80:81], v[148:149]
  v_pk_mul_f32 v[82:83], v[82:83], v[150:151]
  v_cvt_pk_bf16_f32 v164, v76, v77
  v_cvt_pk_bf16_f32 v165, v78, v79
  v_cvt_pk_bf16_f32 v166, v80, v81
  v_cvt_pk_bf16_f32 v167, v82, v83
  ds_read_b128 v[192:195], v122 offset:6496
  s_waitcnt lgkmcnt(3)
  v_mfma_f32_32x32x16_bf16 v[128:143], v[180:183], a[88:91], v[128:143]
  buffer_load_dwordx4 a[12:15], v117, s[12:15], s83 offen offset:2048
  v_cndmask_b32 v164, 0, v164, s[76:77]
  v_cndmask_b32 v165, 0, v165, s[76:77]
  v_cndmask_b32 v166, 0, v166, s[76:77]
  v_cndmask_b32 v167, 0, v167, s[76:77]
  ds_write_b64 v120, v[164:165] offset:32
  ds_write_b64 v120, v[166:167] offset:48
  ds_read_b128 v[172:175], v122 offset:128
  s_waitcnt lgkmcnt(5)
  v_mfma_f32_32x32x16_bf16 v[128:143], v[184:187], a[92:95], v[128:143]
  v_pk_fma_f32 v[92:93], v[92:93], v[34:35], v[60:61]
  v_pk_fma_f32 v[94:95], v[94:95], v[36:37], v[62:63]
  v_pk_fma_f32 v[96:97], v[96:97], v[38:39], v[64:65]
  v_pk_fma_f32 v[98:99], v[98:99], v[40:41], v[66:67]
  ds_read_b128 v[176:179], v122 offset:400
  buffer_load_dwordx4 a[16:19], v117, s[12:15], s83 offen offset:3072
  s_waitcnt lgkmcnt(5)
  v_mfma_f32_32x32x16_bf16 v[128:143], v[188:191], a[96:99], v[128:143]
  v_pk_mul_f32 v[144:145], v[92:93], s[16:17]
  v_pk_mul_f32 v[146:147], v[94:95], s[16:17]
  v_pk_mul_f32 v[148:149], v[96:97], s[16:17]
  v_pk_mul_f32 v[150:151], v[98:99], s[16:17]
  v_exp_f32 v144, v144
  ds_read_b128 v[180:183], v122 offset:672
  s_waitcnt lgkmcnt(5)
  v_mfma_f32_32x32x16_bf16 v[128:143], v[192:195], a[100:103], v[128:143]
  s_mov_b32 s83, 2445312
  buffer_load_dwordx4 a[20:23], v117, s[12:15], s83 offen offset:0
  v_exp_f32 v145, v145
  ds_read_b128 v[184:187], v122 offset:3072
  s_waitcnt lgkmcnt(3)
  v_mfma_f32_32x32x16_bf16 v[128:143], v[172:175], a[104:107], v[128:143]
  buffer_load_dwordx4 a[24:27], v117, s[12:15], s83 offen offset:1024
  v_exp_f32 v146, v146
  v_exp_f32 v147, v147
  ds_read_b128 v[188:191], v122 offset:3344
  s_waitcnt lgkmcnt(3)
  v_mfma_f32_32x32x16_bf16 v[128:143], v[176:179], a[108:111], v[128:143]
  s_mov_b32 s83, 2453504
  buffer_load_dwordx4 a[28:31], v117, s[12:15], s83 offen offset:3072
  v_exp_f32 v148, v148
  ds_read_b128 v[192:195], v122 offset:3616
  s_waitcnt lgkmcnt(3)
  v_mfma_f32_32x32x16_bf16 v[128:143], v[180:183], a[112:115], v[128:143]
  s_mov_b32 s83, 2457600
  buffer_load_dwordx4 a[32:35], v117, s[12:15], s83 offen offset:0
  v_exp_f32 v149, v149
  v_exp_f32 v150, v150
  ds_read_b128 v[172:175], v122 offset:6016
  s_waitcnt lgkmcnt(3)
  v_mfma_f32_32x32x16_bf16 v[128:143], v[184:187], a[116:119], v[128:143]
  v_exp_f32 v151, v151
  ds_read_b128 v[176:179], v122 offset:6288
  buffer_load_dwordx4 a[36:39], v117, s[12:15], s83 offen offset:1024
  s_waitcnt lgkmcnt(3)
  v_mfma_f32_32x32x16_bf16 v[128:143], v[188:191], a[120:123], v[128:143]
  v_pk_add_f32 v[144:145], v[144:145], s[18:19]
  v_pk_add_f32 v[146:147], v[146:147], s[18:19]
  v_pk_add_f32 v[148:149], v[148:149], s[18:19]
  v_pk_add_f32 v[150:151], v[150:151], s[18:19]
  v_rcp_f32 v144, v144
  ds_read_b128 v[180:183], v122 offset:6560
  s_waitcnt lgkmcnt(3)
  v_mfma_f32_32x32x16_bf16 v[128:143], v[192:195], a[124:127], v[128:143]
  buffer_load_dwordx4 a[40:43], v117, s[12:15], s83 offen offset:2048
  v_rcp_f32 v145, v145
  ds_read_b128 v[184:187], v122 offset:192
  s_waitcnt lgkmcnt(3)
  v_mfma_f32_32x32x16_bf16 v[128:143], v[172:175], a[128:131], v[128:143]
  buffer_load_dwordx4 a[44:47], v117, s[12:15], s83 offen offset:3072
  v_rcp_f32 v146, v146
  v_rcp_f32 v147, v147
  ds_read_b128 v[188:191], v122 offset:464
  s_waitcnt lgkmcnt(3)
  v_mfma_f32_32x32x16_bf16 v[128:143], v[176:179], a[132:135], v[128:143]
  s_mov_b32 s83, 2461696
  buffer_load_dwordx4 a[48:51], v117, s[12:15], s83 offen offset:0
  v_rcp_f32 v148, v148
  ds_read_b128 v[192:195], v122 offset:736
  s_waitcnt lgkmcnt(3)
  v_mfma_f32_32x32x16_bf16 v[128:143], v[180:183], a[136:139], v[128:143]
  buffer_load_dwordx4 a[52:55], v117, s[12:15], s83 offen offset:1024
  v_rcp_f32 v149, v149
  v_rcp_f32 v150, v150
  ds_read_b128 v[172:175], v122 offset:3136
  s_waitcnt vmcnt(42) lgkmcnt(3)
  v_mfma_f32_32x32x16_bf16 v[128:143], v[184:187], a[140:143], v[128:143]
  v_rcp_f32 v151, v151
  ds_read_b128 v[176:179], v122 offset:3408
  buffer_load_dwordx4 a[56:59], v117, s[12:15], s83 offen offset:2048
  s_waitcnt vmcnt(42) lgkmcnt(3)
  v_mfma_f32_32x32x16_bf16 v[128:143], v[188:191], a[144:147], v[128:143]
  v_pk_mul_f32 v[92:93], v[92:93], v[144:145]
  v_pk_mul_f32 v[94:95], v[94:95], v[146:147]
  v_pk_mul_f32 v[96:97], v[96:97], v[148:149]
  v_pk_mul_f32 v[98:99], v[98:99], v[150:151]
  v_cvt_pk_bf16_f32 v168, v92, v93
  v_cvt_pk_bf16_f32 v169, v94, v95
  ds_read_b128 v[180:183], v122 offset:3680
  s_waitcnt vmcnt(41) lgkmcnt(3)
  v_mfma_f32_32x32x16_bf16 v[128:143], v[192:195], a[148:151], v[128:143]
  buffer_load_dwordx4 a[60:63], v117, s[12:15], s83 offen offset:3072
  v_cvt_pk_bf16_f32 v170, v96, v97
  v_cvt_pk_bf16_f32 v171, v98, v99
  v_cndmask_b32 v168, 0, v168, s[78:79]
  v_cndmask_b32 v169, 0, v169, s[78:79]
  v_cndmask_b32 v170, 0, v170, s[78:79]
  v_cndmask_b32 v171, 0, v171, s[78:79]
  ds_read_b128 v[184:187], v122 offset:6080
  s_waitcnt vmcnt(41) lgkmcnt(3)
  v_mfma_f32_32x32x16_bf16 v[128:143], v[172:175], a[152:155], v[128:143]
  s_mov_b64 exec, s[80:81]
  ds_write_b64 v121, v[168:169] offset:32
  ds_write_b64 v121, v[170:171] offset:48
  s_mov_b64 exec, -1
  ds_read_b128 v[188:191], v122 offset:6352
  s_waitcnt vmcnt(40) lgkmcnt(5)
  v_mfma_f32_32x32x16_bf16 v[128:143], v[176:179], a[156:159], v[128:143]
  ds_read_b128 v[192:195], v122 offset:6624
  s_waitcnt vmcnt(39) lgkmcnt(5)
  v_mfma_f32_32x32x16_bf16 v[128:143], v[180:183], a[160:163], v[128:143]
  s_waitcnt lgkmcnt(0)
  s_barrier
  ds_read_b128 v[172:175], v122 offset:32
  s_waitcnt vmcnt(38)
  v_mfma_f32_32x32x16_bf16 v[128:143], v[184:187], a[164:167], v[128:143]
  ds_read_b128 v[176:179], v122 offset:304
  s_waitcnt vmcnt(37)
  v_mfma_f32_32x32x16_bf16 v[128:143], v[188:191], a[168:171], v[128:143]
  ds_read_b128 v[180:183], v122 offset:576
  s_waitcnt vmcnt(36)
  v_mfma_f32_32x32x16_bf16 v[128:143], v[192:195], a[172:175], v[128:143]
  ds_read_b128 v[184:187], v122 offset:2976
  s_waitcnt vmcnt(35) lgkmcnt(3)
  v_mfma_f32_32x32x16_bf16 v[128:143], v[172:175], a[176:179], v[128:143]
  ds_read_b128 v[188:191], v122 offset:3248
  s_waitcnt vmcnt(34) lgkmcnt(3)
  v_mfma_f32_32x32x16_bf16 v[128:143], v[176:179], a[180:183], v[128:143]
  ds_read_b128 v[192:195], v122 offset:3520
  s_waitcnt vmcnt(33) lgkmcnt(3)
  v_mfma_f32_32x32x16_bf16 v[128:143], v[180:183], a[184:187], v[128:143]
  ds_read_b128 v[172:175], v122 offset:5920
  s_waitcnt vmcnt(32) lgkmcnt(3)
  v_mfma_f32_32x32x16_bf16 v[128:143], v[184:187], a[188:191], v[128:143]
  ds_read_b128 v[176:179], v122 offset:6192
  s_waitcnt vmcnt(31) lgkmcnt(3)
  v_mfma_f32_32x32x16_bf16 v[128:143], v[188:191], a[192:195], v[128:143]
  ds_read_b128 v[180:183], v122 offset:6464
  s_waitcnt vmcnt(30) lgkmcnt(3)
  v_mfma_f32_32x32x16_bf16 v[128:143], v[192:195], a[196:199], v[128:143]
  ds_read_b128 v[184:187], v122 offset:96
  s_waitcnt vmcnt(29) lgkmcnt(3)
  v_mfma_f32_32x32x16_bf16 v[128:143], v[172:175], a[200:203], v[128:143]
  ds_read_b128 v[188:191], v122 offset:368
  s_waitcnt vmcnt(28) lgkmcnt(3)
  v_mfma_f32_32x32x16_bf16 v[128:143], v[176:179], a[204:207], v[128:143]
  ds_read_b128 v[192:195], v122 offset:640
  s_waitcnt vmcnt(27) lgkmcnt(3)
  v_mfma_f32_32x32x16_bf16 v[128:143], v[180:183], a[208:211], v[128:143]
  ds_read_b128 v[172:175], v122 offset:3040
  s_waitcnt vmcnt(26) lgkmcnt(3)
  v_mfma_f32_32x32x16_bf16 v[128:143], v[184:187], a[212:215], v[128:143]
  ds_read_b128 v[176:179], v122 offset:3312
  s_waitcnt vmcnt(25) lgkmcnt(3)
  v_mfma_f32_32x32x16_bf16 v[128:143], v[188:191], a[216:219], v[128:143]
  ds_read_b128 v[180:183], v122 offset:3584
  s_waitcnt vmcnt(24) lgkmcnt(3)
  v_mfma_f32_32x32x16_bf16 v[128:143], v[192:195], a[220:223], v[128:143]
  ds_read_b128 v[184:187], v122 offset:5984
  s_waitcnt vmcnt(23) lgkmcnt(3)
  v_mfma_f32_32x32x16_bf16 v[128:143], v[172:175], a[224:227], v[128:143]
  ds_read_b128 v[188:191], v122 offset:6256
  s_waitcnt vmcnt(22) lgkmcnt(3)
  v_mfma_f32_32x32x16_bf16 v[128:143], v[176:179], a[228:231], v[128:143]
  ds_read_b128 v[192:195], v122 offset:6528
  s_waitcnt vmcnt(21) lgkmcnt(3)
  v_mfma_f32_32x32x16_bf16 v[128:143], v[180:183], a[232:235], v[128:143]
  ds_read_b128 v[172:175], v122 offset:160
  s_waitcnt vmcnt(20) lgkmcnt(3)
  v_mfma_f32_32x32x16_bf16 v[128:143], v[184:187], a[236:239], v[128:143]
  ds_read_b128 v[176:179], v122 offset:432
  s_waitcnt vmcnt(19) lgkmcnt(3)
  v_mfma_f32_32x32x16_bf16 v[128:143], v[188:191], a[240:243], v[128:143]
  ds_read_b128 v[180:183], v122 offset:704
  s_waitcnt vmcnt(18) lgkmcnt(3)
  v_mfma_f32_32x32x16_bf16 v[128:143], v[192:195], a[244:247], v[128:143]
  ds_read_b128 v[184:187], v122 offset:3104
  s_waitcnt vmcnt(17) lgkmcnt(3)
  v_mfma_f32_32x32x16_bf16 v[128:143], v[172:175], a[248:251], v[128:143]
  ds_read_b128 v[188:191], v122 offset:3376
  s_waitcnt vmcnt(16) lgkmcnt(3)
  v_mfma_f32_32x32x16_bf16 v[128:143], v[176:179], a[252:255], v[128:143]
  ds_read_b128 v[192:195], v122 offset:3648
  s_waitcnt vmcnt(15) lgkmcnt(3)
  v_mfma_f32_32x32x16_bf16 v[128:143], v[180:183], a[0:3], v[128:143]
  ds_read_b128 v[172:175], v122 offset:6048
  s_waitcnt vmcnt(14) lgkmcnt(3)
  v_mfma_f32_32x32x16_bf16 v[128:143], v[184:187], a[4:7], v[128:143]
  ds_read_b128 v[176:179], v122 offset:6320
  s_waitcnt vmcnt(13) lgkmcnt(3)
  v_mfma_f32_32x32x16_bf16 v[128:143], v[188:191], a[8:11], v[128:143]
  ds_read_b128 v[180:183], v122 offset:6592
  s_waitcnt vmcnt(12) lgkmcnt(3)
  v_mfma_f32_32x32x16_bf16 v[128:143], v[192:195], a[12:15], v[128:143]
  ds_read_b128 v[184:187], v122 offset:224
  s_waitcnt vmcnt(11) lgkmcnt(3)
  v_mfma_f32_32x32x16_bf16 v[128:143], v[172:175], a[16:19], v[128:143]
  ds_read_b128 v[188:191], v122 offset:496
  s_waitcnt vmcnt(10) lgkmcnt(3)
  v_mfma_f32_32x32x16_bf16 v[128:143], v[176:179], a[20:23], v[128:143]
  ds_read_b128 v[192:195], v122 offset:768
  s_waitcnt vmcnt(9) lgkmcnt(3)
  v_mfma_f32_32x32x16_bf16 v[128:143], v[180:183], a[24:27], v[128:143]
  ds_read_b128 v[172:175], v122 offset:3168
  s_waitcnt vmcnt(8) lgkmcnt(3)
  v_mfma_f32_32x32x16_bf16 v[128:143], v[184:187], a[28:31], v[128:143]
  ds_read_b128 v[176:179], v122 offset:3440
  s_waitcnt vmcnt(7) lgkmcnt(3)
  v_mfma_f32_32x32x16_bf16 v[128:143], v[188:191], a[32:35], v[128:143]
  ds_read_b128 v[180:183], v122 offset:3712
  s_waitcnt vmcnt(6) lgkmcnt(3)
  v_mfma_f32_32x32x16_bf16 v[128:143], v[192:195], a[36:39], v[128:143]
  ds_read_b128 v[184:187], v122 offset:6112
  s_waitcnt vmcnt(5) lgkmcnt(3)
  v_mfma_f32_32x32x16_bf16 v[128:143], v[172:175], a[40:43], v[128:143]
  ds_read_b128 v[188:191], v122 offset:6384
  s_waitcnt vmcnt(4) lgkmcnt(3)
  v_mfma_f32_32x32x16_bf16 v[128:143], v[176:179], a[44:47], v[128:143]
  ds_read_b128 v[192:195], v122 offset:6656
  s_waitcnt vmcnt(3) lgkmcnt(3)
  v_mfma_f32_32x32x16_bf16 v[128:143], v[180:183], a[48:51], v[128:143]
  s_waitcnt vmcnt(2) lgkmcnt(2)
  v_mfma_f32_32x32x16_bf16 v[128:143], v[184:187], a[52:55], v[128:143]
  s_waitcnt vmcnt(1) lgkmcnt(1)
  v_mfma_f32_32x32x16_bf16 v[128:143], v[188:191], a[56:59], v[128:143]
  s_waitcnt vmcnt(0) lgkmcnt(0)
  v_mfma_f32_32x32x16_bf16 v[128:143], v[192:195], a[60:63], v[128:143]
  s_nop 11
  v_cvt_pk_bf16_f32 v164, v128, v129
  v_cvt_pk_bf16_f32 v165, v130, v131
  v_cvt_pk_bf16_f32 v166, v132, v133
  v_cvt_pk_bf16_f32 v167, v134, v135
  v_cvt_pk_bf16_f32 v168, v136, v137
  v_cvt_pk_bf16_f32 v169, v138, v139
  v_cvt_pk_bf16_f32 v170, v140, v141
  v_cvt_pk_bf16_f32 v171, v142, v143
  v_permlane32_swap_b32 v164, v166
  v_permlane32_swap_b32 v165, v167
  v_permlane32_swap_b32 v168, v170
  v_permlane32_swap_b32 v169, v171
  global_store_dwordx4 v16, v[164:167], s[54:55] offset:0
  global_store_dwordx4 v16, v[168:171], s[54:55] offset:256
  s_or_b32 s22, s2, s4
  s_cmp_eq_u32 s22, 0
  s_cbranch_scc0 F_FIN
  s_mov_b32 s82, 65536
  s_nop 7
  s_nop 3
F_POLL3:
  v_cmp_eq_u64 vcc, s[64:65], v[104:105]
  v_cmp_eq_u64 s[22:23], s[64:65], v[108:109]
  s_sub_u32 s82, s82, 1
  s_cbranch_scc1 F_GO3
  s_and_b64 vcc, vcc, s[22:23]
  s_cmp_eq_u64 vcc, -1
  s_cbranch_scc1 F_GO3
  buffer_load_dwordx4 v[102:105], v13, s[12:15], 0 offen sc0 sc1
  buffer_load_dwordx4 v[106:109], v13, s[12:15], 0 offen offset:16 sc0 sc1
  s_waitcnt vmcnt(0)
  s_branch F_POLL3
F_GO3:
  v_mov_b32 v2, 2692096
  v_mov_b32 v152, s64
  v_mov_b32 v153, s65
  s_mov_b64 exec, 1
  global_store_dwordx2 v2, v[152:153], s[58:59] sc0 sc1
  s_mov_b64 exec, -1
F_FIN:
F_END:
  s_endpgm
.section .rodata,"a"
.p2align 6
.amdhsa_kernel standalone__adm_resblock__diffusion_kernel
  .amdhsa_next_free_vgpr 512
  .amdhsa_next_free_sgpr 102
  .amdhsa_accum_offset 256
  .amdhsa_group_segment_fixed_size 0
  .amdhsa_kernarg_size 96
  .amdhsa_user_sgpr_count 2
  .amdhsa_user_sgpr_kernarg_segment_ptr 1
  .amdhsa_system_sgpr_workgroup_id_x 1
.end_amdhsa_kernel
```
